```python
import torch

def _softmax(x, axis=-1):
    return torch.softmax(x, dim=axis)
def _gelu(x):
    return torch.nn.functional.gelu(x, approximate="tanh")
def _silu(x):
    return torch.nn.functional.silu(x)
def _sigmoid(x):
    return torch.sigmoid(x)
def _layernorm(x, axis=-1, eps=1e-5):
    m = x.mean(dim=axis, keepdim=True)
    v = x.var(dim=axis, keepdim=True, unbiased=False)
    return (x - m) / torch.sqrt(v + eps)
def _scatter_add(tgt, idx, src, axis=0):
    return tgt.clone().index_add_(axis, idx, src)
def _segment_sum(src, seg, n):
    out = torch.zeros((n,) + src.shape[1:], dtype=src.dtype)
    return out.index_add_(0, seg, src)
def _pad(x, pw):
    flat = tuple(v for pair in reversed(pw) for v in pair)
    return torch.nn.functional.pad(x, flat)

kernel_name = 'sequential_preLN__sliding_block__dense_activation_relu__prompt'

def setup_inputs():

    _w = (lambda a: (lambda t: t.to(torch.bfloat16) if t.is_floating_point() else t)(torch.as_tensor(a)))
    def _A_setup():
        B, S, D = 1, 2048, 448
        return {
            "x": _w((lambda *s: torch.randn(*s, dtype=torch.bfloat16) * 0.05)(B, S, D)),
            "wqkv": _w((lambda *s: torch.randn(*s, dtype=torch.bfloat16) * 0.05)(D, 3 * D)),
            "wo": _w((lambda *s: torch.randn(*s, dtype=torch.bfloat16) * 0.05)(D, D)),
        }
    _A_in = _A_setup()

    def _B_setup():
        B, S, D, Dff = 1, 2048, 448, 1792
        return {
            "x": _w((lambda *s: torch.randn(*s, dtype=torch.bfloat16) * 0.05)(B, S, D)),
            "w1": _w((lambda *s: torch.randn(*s, dtype=torch.bfloat16) * 0.05)(D, Dff)),
            "w2": _w((lambda *s: torch.randn(*s, dtype=torch.bfloat16) * 0.05)(Dff, D)),
        }
    _B_in = _B_setup()

    return {
        "A_x": _A_in["x"],
        "A_wqkv": _A_in["wqkv"],
        "A_wo": _A_in["wo"],
        "B_x": _B_in["x"],
        "B_w1": _B_in["w1"],
        "B_w2": _B_in["w2"],
    }

def reference(A_x, A_wqkv, A_wo, B_x, B_w1, B_w2):
    def _A_ref(x, wqkv, wo):
        B, S, D = x.shape
        H = 16; Dh = D // H; W = 256
        qkv = (lambda x, *d: x.permute(*d))((x @ wqkv).reshape(B, S, 3, H, Dh), 2, 0, 3, 1, 4)
        q, k, v = qkv[0], qkv[1], qkv[2]
        scores = torch.einsum("bhqd,bhkd->bhqk", q, k) * (Dh ** -0.5)
        idx = torch.arange(S)
        mask = (idx[:, None] - idx[None, :] >= 0) & (idx[:, None] - idx[None, :] < W)
        scores = torch.where(mask[None, None], scores, -1e9)
        p = _softmax(scores, axis=-1)
        o = torch.einsum("bhqk,bhkd->bhqd", p, v)
        return (lambda x, *d: x.permute(*d))(o, 0, 2, 1, 3).reshape(B, S, D) @ wo

    def _B_ref(x, w1, w2):
        h = torch.einsum("bsd,df->bsf", x, w1)
        zero = torch.zeros_like(h)
        h = torch.maximum(h, zero)
        return torch.einsum("bsf,fd->bsd", h, w2)

    x = A_x
    h = x + _A_ref(_layernorm(x, axis=-1), A_wqkv, A_wo)
    h2 = h + _B_ref(_layernorm(h, axis=-1), B_w1, B_w2)
    return h2
```

```asm
; @launch grid=(256,1,1) block=(512,1,1) lds=163840
.amdgcn_target "amdgcn-amd-amdhsa--gfx950"
.text
.globl sequential_preLN__sliding_block__dense_activation_relu__prompt_kernel
.p2align 8
.type sequential_preLN__sliding_block__dense_activation_relu__prompt_kernel,@function
sequential_preLN__sliding_block__dense_activation_relu__prompt_kernel:
    s_cmp_ge_u32 s2, 256
    s_cbranch_scc1 L_END
    s_load_dwordx16 s[72:87], s[0:1], 0
    s_load_dwordx2 s[88:89], s[0:1], 64
    v_and_b32 v1, 63, v0
    v_lshrrev_b32 v2, 6, v0
    s_nop 0
    v_readfirstlane_b32 s58, v2
    s_nop 1
    s_and_b32 s59, s58, 3
    s_lshr_b32 s60, s58, 2
    s_and_b32 s56, s2, 7
    s_lshl_b32 s56, s56, 1
    s_lshr_b32 s63, s2, 7
    s_add_u32 s56, s56, s63
    s_lshr_b32 s57, s2, 3
    s_and_b32 s57, s57, 15
    s_getreg_b32 s61, hwreg(HW_REG_XCC_ID)
    s_and_b32 s61, s61, 15
    s_mov_b32 s96, 0x3f803f80
    s_cmp_ge_u32 s57, 7
    s_cselect_b32 s97, 1, 0
    s_mul_i32 s63, s97, 7
    s_sub_u32 s23, s57, s63
    s_mov_b32 s20, 0
    s_mov_b32 s21, -1
    s_cmp_lt_u32 s57, 14
    s_cselect_b32 s17, 1, 0
    v_mov_b32 v84, 0
    v_mov_b32 v85, 0
    s_cmp_eq_u32 s17, 0
    s_cbranch_scc1 PADW_1
    s_and_b32 s94, s56, 12
    s_and_b32 s3, s56, 1
    s_lshl_b32 s3, s3, 1
    s_add_u32 s3, s3, s97
    s_add_u32 s94, s94, s3
    s_bfe_u32 s95, s56, 0x10001
    s_mul_i32 s95, s95, 7
    s_add_u32 s95, s95, s23
    s_cmp_eq_u32 s60, 1
    s_cbranch_scc1 P1R1_3
    s_and_b32 s3, s94, 3
    s_lshl_b32 s3, s3, 1
    s_add_u32 s3, s3, s23
    s_sub_u32 s4, s3, 7
    s_cmp_ge_u32 s3, 7
    s_cselect_b32 s3, s4, s3
    s_mul_i32 s4, s3, 64
    s_lshr_b32 s4, s4, 8
    s_mul_i32 s4, s4, 4
    s_sub_u32 s3, s3, s4
    s_lshl_b32 s64, s3, 7
    s_mul_i32 s3, s59, 43008
    s_mul_i32 s4, s95, 192
    s_add_u32 s3, s3, s4
    v_add_u32 v14, 0, v1
    v_mul_u32_u24 v15, 43691, v14
    v_lshrrev_b32 v15, 19, v15
    v_mul_u32_u24 v15, 2496, v15
    v_lshl_add_u32 v15, v1, 4, v15
    v_add_u32 v104, s3, v15
    v_add_u32 v14, 64, v1
    v_mul_u32_u24 v15, 43691, v14
    v_lshrrev_b32 v15, 19, v15
    v_mul_u32_u24 v15, 2496, v15
    v_lshl_add_u32 v15, v1, 4, v15
    v_add_u32 v105, s3, v15
    v_add_u32 v14, 128, v1
    v_mul_u32_u24 v15, 43691, v14
    v_lshrrev_b32 v15, 19, v15
    v_mul_u32_u24 v15, 2496, v15
    v_lshl_add_u32 v15, v1, 4, v15
    v_add_u32 v106, s3, v15
    s_mul_i32 s8, s59, 3072
    s_waitcnt lgkmcnt(0)
    s_mov_b32 s24, s72
    s_and_b32 s25, s73, 0xffff
    s_mov_b32 s26, 1835008
    s_mov_b32 s27, 0x20000
    s_mov_b32 s28, s74
    s_and_b32 s29, s75, 0xffff
    s_mov_b32 s30, 1204224
    s_mov_b32 s31, 0x20000
    s_mul_i32 s4, s64, 1344
    s_add_u32 m0, s8, 65536
    s_nop 0
    buffer_load_dwordx4 v104, s[28:31], s4 offen lds
    buffer_load_dwordx4 v105, s[28:31], s4 offen offset:1024 lds
    buffer_load_dwordx4 v106, s[28:31], s4 offen offset:2048 lds
    s_mov_b32 s32, s76
    s_and_b32 s33, s77, 0xffff
    s_mov_b32 s34, 401408
    s_mov_b32 s35, 0x20000
    s_mov_b32 s36, s80
    s_and_b32 s37, s81, 0xffff
    s_mov_b32 s38, 1605632
    s_mov_b32 s39, 0x20000
    s_mov_b32 s40, s82
    s_and_b32 s41, s83, 0xffff
    s_mov_b32 s42, 1605632
    s_mov_b32 s43, 0x20000
    s_mov_b32 s44, s84
    s_and_b32 s45, s85, 0xffff
    s_mov_b32 s46, 1835008
    s_mov_b32 s47, 0x20000
    s_mov_b32 s48, s86
    s_and_b32 s49, s87, 0xffff
    s_mov_b32 s50, 256
    s_mov_b32 s51, 0x20000
    s_mov_b32 s52, s88
    s_and_b32 s53, s89, 0xffff
    s_mov_b32 s54, 41943040
    s_mov_b32 s55, 0x20000
    v_and_b32 v14, 31, v1
    v_bfe_u32 v15, v1, 1, 3
    v_lshrrev_b32 v120, 5, v1
    v_xor_b32 v15, v15, v120
    s_lshl_b32 s4, s59, 12
    v_lshl_add_u32 v14, v14, 7, s4
    s_add_u32 s3, s59, 0
    s_and_b32 s3, s3, 3
    s_lshl_b32 s4, s3, 1
    s_mul_i32 s10, s3, 3072
    v_xor_b32 v120, s4, v15
    v_lshl_add_u32 v120, v120, 4, v14
    s_add_u32 s3, s59, 1
    s_and_b32 s3, s3, 3
    s_lshl_b32 s4, s3, 1
    s_mul_i32 s11, s3, 3072
    v_xor_b32 v121, s4, v15
    v_lshl_add_u32 v121, v121, 4, v14
    s_add_u32 s3, s59, 2
    s_and_b32 s3, s3, 3
    s_lshl_b32 s4, s3, 1
    s_mul_i32 s12, s3, 3072
    v_xor_b32 v122, s4, v15
    v_lshl_add_u32 v122, v122, 4, v14
    s_add_u32 s3, s59, 3
    s_and_b32 s3, s3, 3
    s_lshl_b32 s4, s3, 1
    s_mul_i32 s13, s3, 3072
    v_xor_b32 v123, s4, v15
    v_lshl_add_u32 v123, v123, 4, v14
    v_lshrrev_b32 v14, 5, v1
    v_bfe_u32 v15, v1, 2, 2
    v_lshl_add_u32 v14, v14, 3, v15
    v_mul_u32_u24 v14, 192, v14
    v_bfe_u32 v15, v1, 4, 1
    v_lshl_add_u32 v14, v15, 5, v14
    v_and_b32 v15, 3, v1
    v_lshl_add_u32 v14, v15, 3, v14
    v_add_u32 v14, 65536, v14
    v_add_u32 v124, s10, v14
    v_add_u32 v125, s11, v14
    v_add_u32 v126, s12, v14
    v_add_u32 v127, s13, v14
    v_mov_b32 v108, 0
    v_mov_b32 v109, 0
    v_mov_b32 v134, 0
    v_mov_b32 v135, 0
    s_add_u32 s65, s64, 128
    s_cmp_eq_u32 s65, 512
    s_cselect_b32 s65, 0, s65
    s_mul_i32 s4, s65, 1344
    s_add_u32 m0, s8, 77824
    s_nop 0
    buffer_load_dwordx4 v104, s[28:31], s4 offen lds
    buffer_load_dwordx4 v105, s[28:31], s4 offen offset:1024 lds
    buffer_load_dwordx4 v106, s[28:31], s4 offen offset:2048 lds
    s_and_b32 s4, s58, 1
    s_lshl_b32 s3, s60, 1
    s_add_u32 s3, s3, s4
    s_mul_i32 s3, s3, 14336
    s_add_u32 s3, s3, 65536
    s_mov_b32 s100, 0
    v_lshrrev_b32 v14, 5, v1
    v_lshlrev_b32 v14, 10, v14
    v_bfe_u32 v15, v1, 2, 2
    v_lshl_add_u32 v14, v15, 7, v14
    v_bfe_u32 v15, v1, 4, 1
    v_lshl_add_u32 v14, v15, 5, v14
    v_and_b32 v15, 3, v1
    v_lshl_add_u32 v14, v15, 3, v14
    v_bfe_u32 v15, v1, 3, 1
    v_lshlrev_b32 v15, 6, v15
    v_xor_b32 v15, s100, v15
    v_add_u32 v14, v14, v15
    v_add_u32 v58, s3, v14
    v_xor_b32 v57, 64, v58
    s_lshl_b32 s100, s4, 6
    s_and_b32 s4, s58, 2
    s_lshl_b32 s4, s4, 4
    v_and_b32 v14, 31, v1
    v_add_u32 v14, s4, v14
    s_lshl_b32 s3, s60, 5
    s_add_u32 s3, s3, s100
    v_lshrrev_b32 v15, 5, v1
    v_lshl_add_u32 v15, v15, 3, s3
    v_bfe_u32 v59, v1, 1, 1
    v_lshlrev_b32 v59, 6, v59
    v_xor_b32 v59, v59, v15
    v_lshl_add_u32 v59, v14, 7, v59
    v_add_u32 v59, 122880, v59
    s_lshl_b32 s3, s56, 7
    s_lshl_b32 s4, s97, 6
    s_add_u32 s3, s3, s4
    v_add_u32 v14, s3, v14
    v_mul_u32_u24 v14, 896, v14
    s_lshl_b32 s3, s23, 7
    v_add3_u32 v85, v14, v15, s3
    s_mul_i32 s3, s57, 7
    s_lshr_b32 s3, s3, 1
    v_lshrrev_b32 v14, 5, v1
    v_and_b32 v69, 31, v1
    v_add3_u32 v15, v14, s3, 0
    v_lshrrev_b32 v65, 2, v15
    v_lshlrev_b32 v65, 17, v65
    v_and_b32 v15, 3, v15
    v_lshl_add_u32 v65, v15, 9, v65
    v_add3_u32 v15, v14, s3, 2
    v_lshrrev_b32 v66, 2, v15
    v_lshlrev_b32 v66, 17, v66
    v_and_b32 v15, 3, v15
    v_lshl_add_u32 v66, v15, 9, v66
    s_and_b32 s82, s58, 1
    s_cmp_eq_u32 s82, 1
    s_cselect_b64 s[18:19], -1, 0
    v_cndmask_b32 v68, v65, v66, s[18:19]
    v_lshl_add_u32 v67, v69, 4, v68
    s_lshl_b32 s4, s82, 1
    v_add_u32 v15, s4, v14
    v_lshlrev_b32 v15, 2, v15
    v_sub_u32 v15, v69, v15
    v_and_b32 v15, 31, v15
    v_lshl_add_u32 v68, v15, 4, v68
    v_lshl_add_u32 v65, v69, 4, v65
    v_lshl_add_u32 v66, v69, 4, v66
    s_lshl_b32 s4, s56, 2
    s_add_u32 s5, s4, s59
    s_lshl_b32 s72, s5, 11
    s_lshl_b32 s6, s57, 17
    s_add_u32 s73, s72, s6
    s_add_u32 s73, s73, 6291456
    s_lshr_b32 s6, s58, 1
    s_mul_i32 s6, s6, 3
    s_add_u32 s4, s4, s6
    s_add_u32 s4, s4, 888
    s_lshl_b32 s74, s4, 11
    s_lshl_b32 s6, s6, 11
    s_lshl_b32 s75, s82, 10
    s_add_u32 s75, s75, s6
    s_lshl_b32 s3, s60, 2
    s_sub_u32 s76, s59, s3
    s_add_u32 s76, s76, 4
    s_lshl_b32 s3, s76, 11
    s_add_u32 s3, s3, 90112
    v_lshl_add_u32 v2, v1, 4, s3
    v_bfe_u32 v14, v1, 4, 1
    v_and_b32 v3, 3, v1
    v_lshl_add_u32 v14, v14, 2, v3
    v_lshrrev_b32 v15, 1, v14
    v_lshrrev_b32 v3, 5, v1
    v_add_u32 v3, v3, v15
    v_bfe_u32 v4, v1, 2, 2
    v_lshl_add_u32 v8, v3, 2, v4
    v_lshl_add_u32 v15, v15, 9, s3
    v_and_b32 v3, 1, v1
    v_lshl_add_u32 v15, v3, 3, v15
    v_add_u32 v15, 24576, v15
    s_and_b32 s4, s57, 1
    s_mul_i32 s4, s4, 7
    s_sub_u32 s4, 7, s4
    v_cmp_eq_u32 s[18:19], s4, v14
    v_mov_b32 v14, 140288
    v_add_u32 v3, 0, v8
    v_and_b32 v3, 31, v3
    v_lshl_add_u32 v3, v3, 4, v15
    v_cndmask_b32 v3, v3, v14, s[18:19]
    v_add_u32 v4, 8, v8
    v_and_b32 v4, 31, v4
    v_lshl_add_u32 v4, v4, 4, v15
    v_cndmask_b32 v4, v4, v14, s[18:19]
    v_add_u32 v5, 16, v8
    v_and_b32 v5, 31, v5
    v_lshl_add_u32 v5, v5, 4, v15
    v_cndmask_b32 v5, v5, v14, s[18:19]
    v_add_u32 v6, 24, v8
    v_and_b32 v6, 31, v6
    v_lshl_add_u32 v6, v6, 4, v15
    v_cndmask_b32 v6, v6, v14, s[18:19]
    s_lshl_b32 s3, s56, 2
    s_sub_i32 s77, 8, s3
    s_sub_i32 s77, s77, s76
    s_mov_b32 s3, 0
    s_lshl_b32 s5, s57, 8
    v_lshrrev_b32 v14, 3, v1
    v_bfe_u32 v15, v1, 4, 1
    v_lshlrev_b32 v15, 2, v15
    v_xor_b32 v15, v15, v1
    v_and_b32 v15, 7, v15
    v_add_u32 v14, s3, v14
    v_mul_u32_u24 v14, 3584, v14
    v_lshl_add_u32 v14, v15, 4, v14
    v_add_u32 v9, s5, v14
    s_mul_i32 s78, s58, 28672
    s_lshl_b32 s79, s58, 10
    s_mul_i32 s80, s59, 28672
    s_lshl_b32 s81, s59, 10
    s_mul_i32 s3, s59, 4608
    s_add_u32 s3, s3, 139264
    v_lshl_add_u32 v7, v1, 4, s3
    s_lshl_b32 s4, s60, 8
    s_add_u32 s3, s3, s4
    s_add_u32 s3, s3, 4096
    v_lshl_add_u32 v8, v1, 2, s3
    v_xor_b32 v11, 256, v8
    v_lshl_add_u32 v10, v1, 4, s73
    v_lshrrev_b32 v14, 4, v1
    v_sub_u32 v14, s56, v14
    v_max_i32 v14, 0, v14
    v_and_b32 v15, 15, v1
    v_cmp_le_u32 vcc, 7, v15
    s_nop 1
    v_cndmask_b32 v62, 0, 1, vcc
    v_and_b32 v60, 12, v14
    v_lshl_add_u32 v60, v62, 1, v60
    v_bfe_u32 v61, v14, 1, 1
    v_add_u32 v60, v60, v61
    v_and_b32 v61, 1, v14
    v_sub_u32 v61, v61, v62
    v_mad_i32_i24 v61, v61, 7, v15
    v_cmp_le_u32 vcc, 14, v15
    s_nop 1
    v_cndmask_b32 v60, v60, v14, vcc
    v_cndmask_b32 v61, v61, v15, vcc
    v_mov_b32 v62, s56
    v_cmp_le_u32 vcc, 48, v1
    s_nop 1
    v_cndmask_b32 v60, v60, v62, vcc
    v_cndmask_b32 v61, v61, v15, vcc
    v_lshl_add_u32 v60, v60, 4, v61
    v_lshlrev_b32 v14, 7, v60
    v_add_u32 v61, 33685504, v14
    s_mul_i32 s3, s95, 3
    s_add_u32 s3, s3, 0
    s_cmp_lt_u32 s3, 14
    s_cselect_b32 s100, 1, 0
    s_lshl_b32 s3, s3, 6
    s_lshl_b32 s4, s94, 2
    s_add_u32 s3, s3, s4
    s_add_u32 s3, s3, s59
    s_lshl_b32 s3, s3, 11
    v_lshl_add_u32 v136, v1, 4, s3
    s_mul_i32 s3, s95, 3
    s_add_u32 s3, s3, 1
    s_cmp_lt_u32 s3, 14
    s_cselect_b32 s101, 1, 0
    s_lshl_b32 s3, s3, 6
    s_lshl_b32 s4, s94, 2
    s_add_u32 s3, s3, s4
    s_add_u32 s3, s3, s59
    s_lshl_b32 s3, s3, 11
    v_lshl_add_u32 v137, v1, 4, s3
    s_lshl_b32 s3, s59, 9
    s_lshl_b32 s4, s94, 11
    s_add_u32 s3, s3, s4
    s_add_u32 s3, s3, 11534336
    v_mov_b32 v94, 163344
    v_and_b32 v14, 31, v1
    v_lshl_add_u32 v107, v14, 4, s3
    v_lshlrev_b32 v91, 2, v0
    v_add_u32 v91, 153600, v91
    v_lshlrev_b32 v92, 2, v14
    v_add_u32 v92, 153600, v92
    v_add_u32 v93, 1024, v92
    s_waitcnt vmcnt(3) lgkmcnt(0)
    s_barrier
    ds_read_b128 v[144:147], v120 offset:0
    ds_read_b64_tr_b16 v[160:161], v124 offset:0
    ds_read_b64_tr_b16 v[162:163], v124 offset:768
    ds_read_b64_tr_b16 v[176:177], v124 offset:64
    ds_read_b64_tr_b16 v[178:179], v124 offset:832
    ds_read_b128 v[148:151], v121 offset:0
    ds_read_b64_tr_b16 v[164:165], v125 offset:0
    ds_read_b64_tr_b16 v[166:167], v125 offset:768
    ds_read_b64_tr_b16 v[180:181], v125 offset:64
    ds_read_b64_tr_b16 v[182:183], v125 offset:832
    ds_read_b128 v[152:155], v122 offset:0
    ds_read_b64_tr_b16 v[168:169], v126 offset:0
    ds_read_b64_tr_b16 v[170:171], v126 offset:768
    ds_read_b64_tr_b16 v[184:185], v126 offset:64
    ds_read_b64_tr_b16 v[186:187], v126 offset:832
    ds_read_b128 v[156:159], v123 offset:0
    ds_read_b64_tr_b16 v[172:173], v127 offset:0
    ds_read_b64_tr_b16 v[174:175], v127 offset:768
    ds_read_b64_tr_b16 v[188:189], v127 offset:64
    ds_read_b64_tr_b16 v[190:191], v127 offset:832
    s_waitcnt vmcnt(0) lgkmcnt(0)
    s_barrier
    v_dot2c_f32_bf16 v108, s96, v160
    v_dot2c_f32_bf16 v108, s96, v161
    v_dot2c_f32_bf16 v108, s96, v162
    v_dot2c_f32_bf16 v108, s96, v163
    v_dot2c_f32_bf16 v109, s96, v176
    v_dot2c_f32_bf16 v109, s96, v177
    v_dot2c_f32_bf16 v109, s96, v178
    v_dot2c_f32_bf16 v109, s96, v179
    v_mfma_f32_32x32x16_bf16 v[16:31], v[160:163], v[144:147], 0
    ds_read_b128 v[192:195], v120 offset:16384
    ds_read_b64_tr_b16 v[208:209], v124 offset:12288
    v_mfma_f32_32x32x16_bf16 v[32:47], v[176:179], v[144:147], 0
    ds_read_b64_tr_b16 v[210:211], v124 offset:13056
    ds_read_b64_tr_b16 v[224:225], v124 offset:12352
    ds_read_b64_tr_b16 v[226:227], v124 offset:13120
    v_mfma_f32_32x32x16_bf16 v[16:31], v[164:167], v[148:151], v[16:31]
    ds_read_b128 v[196:199], v121 offset:16384
    ds_read_b64_tr_b16 v[212:213], v125 offset:12288
    v_mfma_f32_32x32x16_bf16 v[32:47], v[180:183], v[148:151], v[32:47]
    ds_read_b64_tr_b16 v[214:215], v125 offset:13056
    ds_read_b64_tr_b16 v[228:229], v125 offset:12352
    ds_read_b64_tr_b16 v[230:231], v125 offset:13120
    v_mfma_f32_32x32x16_bf16 v[16:31], v[168:171], v[152:155], v[16:31]
    ds_read_b128 v[200:203], v122 offset:16384
    ds_read_b64_tr_b16 v[216:217], v126 offset:12288
    v_mfma_f32_32x32x16_bf16 v[32:47], v[184:187], v[152:155], v[32:47]
    ds_read_b64_tr_b16 v[218:219], v126 offset:13056
    ds_read_b64_tr_b16 v[232:233], v126 offset:12352
    ds_read_b64_tr_b16 v[234:235], v126 offset:13120
    v_mfma_f32_32x32x16_bf16 v[16:31], v[172:175], v[156:159], v[16:31]
    ds_read_b128 v[204:207], v123 offset:16384
    ds_read_b64_tr_b16 v[220:221], v127 offset:12288
    v_mfma_f32_32x32x16_bf16 v[32:47], v[188:191], v[156:159], v[32:47]
    ds_read_b64_tr_b16 v[222:223], v127 offset:13056
    ds_read_b64_tr_b16 v[236:237], v127 offset:12352
    ds_read_b64_tr_b16 v[238:239], v127 offset:13120
    s_cmp_lg_u32 s58, 3
    s_cbranch_scc1 ON_5
    buffer_load_dwordx2 v[142:143], off, s[48:51], 0 sc1
ON_5:
    s_waitcnt lgkmcnt(0)
    s_barrier
    v_dot2c_f32_bf16 v108, s96, v208
    v_dot2c_f32_bf16 v108, s96, v209
    v_dot2c_f32_bf16 v108, s96, v210
    v_dot2c_f32_bf16 v108, s96, v211
    v_dot2c_f32_bf16 v109, s96, v224
    v_dot2c_f32_bf16 v109, s96, v225
    v_dot2c_f32_bf16 v109, s96, v226
    v_dot2c_f32_bf16 v109, s96, v227
    v_mfma_f32_32x32x16_bf16 v[16:31], v[208:211], v[192:195], v[16:31]
    ds_read_b128 v[144:147], v120 offset:32768
    ds_read_b64_tr_b16 v[160:161], v124 offset:24576
    v_mfma_f32_32x32x16_bf16 v[32:47], v[224:227], v[192:195], v[32:47]
    ds_read_b64_tr_b16 v[162:163], v124 offset:25344
    ds_read_b64_tr_b16 v[176:177], v124 offset:24640
    ds_read_b64_tr_b16 v[178:179], v124 offset:25408
    v_mfma_f32_32x32x16_bf16 v[16:31], v[212:215], v[196:199], v[16:31]
    ds_read_b128 v[148:151], v121 offset:32768
    ds_read_b64_tr_b16 v[164:165], v125 offset:24576
    v_mfma_f32_32x32x16_bf16 v[32:47], v[228:231], v[196:199], v[32:47]
    ds_read_b64_tr_b16 v[166:167], v125 offset:25344
    ds_read_b64_tr_b16 v[180:181], v125 offset:24640
    ds_read_b64_tr_b16 v[182:183], v125 offset:25408
    v_mfma_f32_32x32x16_bf16 v[16:31], v[216:219], v[200:203], v[16:31]
    ds_read_b128 v[152:155], v122 offset:32768
    ds_read_b64_tr_b16 v[168:169], v126 offset:24576
    v_mfma_f32_32x32x16_bf16 v[32:47], v[232:235], v[200:203], v[32:47]
    ds_read_b64_tr_b16 v[170:171], v126 offset:25344
    ds_read_b64_tr_b16 v[184:185], v126 offset:24640
    ds_read_b64_tr_b16 v[186:187], v126 offset:25408
    v_mfma_f32_32x32x16_bf16 v[16:31], v[220:223], v[204:207], v[16:31]
    ds_read_b128 v[156:159], v123 offset:32768
    ds_read_b64_tr_b16 v[172:173], v127 offset:24576
    v_mfma_f32_32x32x16_bf16 v[32:47], v[236:239], v[204:207], v[32:47]
    ds_read_b64_tr_b16 v[174:175], v127 offset:25344
    ds_read_b64_tr_b16 v[188:189], v127 offset:24640
    ds_read_b64_tr_b16 v[190:191], v127 offset:25408
    s_waitcnt lgkmcnt(0)
    s_barrier
    v_dot2c_f32_bf16 v108, s96, v160
    v_dot2c_f32_bf16 v108, s96, v161
    v_dot2c_f32_bf16 v108, s96, v162
    v_dot2c_f32_bf16 v108, s96, v163
    v_dot2c_f32_bf16 v109, s96, v176
    v_dot2c_f32_bf16 v109, s96, v177
    v_dot2c_f32_bf16 v109, s96, v178
    v_dot2c_f32_bf16 v109, s96, v179
    v_mfma_f32_32x32x16_bf16 v[16:31], v[160:163], v[144:147], v[16:31]
    ds_read_b128 v[192:195], v120 offset:49152
    ds_read_b64_tr_b16 v[208:209], v124 offset:36864
    v_mfma_f32_32x32x16_bf16 v[32:47], v[176:179], v[144:147], v[32:47]
    ds_read_b64_tr_b16 v[210:211], v124 offset:37632
    ds_read_b64_tr_b16 v[224:225], v124 offset:36928
    ds_read_b64_tr_b16 v[226:227], v124 offset:37696
    v_mfma_f32_32x32x16_bf16 v[16:31], v[164:167], v[148:151], v[16:31]
    ds_read_b128 v[196:199], v121 offset:49152
    ds_read_b64_tr_b16 v[212:213], v125 offset:36864
    v_mfma_f32_32x32x16_bf16 v[32:47], v[180:183], v[148:151], v[32:47]
    ds_read_b64_tr_b16 v[214:215], v125 offset:37632
    ds_read_b64_tr_b16 v[228:229], v125 offset:36928
    ds_read_b64_tr_b16 v[230:231], v125 offset:37696
    v_mfma_f32_32x32x16_bf16 v[16:31], v[168:171], v[152:155], v[16:31]
    ds_read_b128 v[200:203], v122 offset:49152
    ds_read_b64_tr_b16 v[216:217], v126 offset:36864
    v_mfma_f32_32x32x16_bf16 v[32:47], v[184:187], v[152:155], v[32:47]
    ds_read_b64_tr_b16 v[218:219], v126 offset:37632
    ds_read_b64_tr_b16 v[232:233], v126 offset:36928
    ds_read_b64_tr_b16 v[234:235], v126 offset:37696
    v_mfma_f32_32x32x16_bf16 v[16:31], v[172:175], v[156:159], v[16:31]
    ds_read_b128 v[204:207], v123 offset:49152
    ds_read_b64_tr_b16 v[220:221], v127 offset:36864
    v_mfma_f32_32x32x16_bf16 v[32:47], v[188:191], v[156:159], v[32:47]
    ds_read_b64_tr_b16 v[222:223], v127 offset:37632
    ds_read_b64_tr_b16 v[236:237], v127 offset:36928
    ds_read_b64_tr_b16 v[238:239], v127 offset:37696
    s_cmp_lg_u32 s58, 3
    s_cbranch_scc1 ON_6
    s_waitcnt vmcnt(0)
    s_mov_b32 s22, 200000
    s_nop 15
TOK_7:
    v_readfirstlane_b32 s0, v142
    v_readfirstlane_b32 s1, v143
    s_nop 0
    s_cmp_lg_u32 s0, 0
    s_cbranch_scc1 TOKD_8
    s_sub_u32 s22, s22, 1
    s_cbranch_scc1 TOKD_8
    s_sleep 4
    buffer_load_dwordx2 v[142:143], off, s[48:51], 0 sc1
    s_waitcnt vmcnt(0)
    s_branch TOK_7
TOKD_8:
    v_mov_b32 v14, 163344
    ds_write_b64 v14, v[142:143]
ON_6:
    s_waitcnt lgkmcnt(0)
    s_barrier
    v_add_u32 v124, 49152, v124
    v_add_u32 v125, 49152, v125
    v_add_u32 v126, 49152, v126
    v_add_u32 v127, 49152, v127
    v_dot2c_f32_bf16 v108, s96, v208
    v_dot2c_f32_bf16 v108, s96, v209
    v_dot2c_f32_bf16 v108, s96, v210
    v_dot2c_f32_bf16 v108, s96, v211
    v_dot2c_f32_bf16 v109, s96, v224
    v_dot2c_f32_bf16 v109, s96, v225
    v_dot2c_f32_bf16 v109, s96, v226
    v_dot2c_f32_bf16 v109, s96, v227
    v_mfma_f32_32x32x16_bf16 v[16:31], v[208:211], v[192:195], v[16:31]
    ds_read_b128 v[144:147], v120 offset:0
    ds_read_b64_tr_b16 v[160:161], v124 offset:0
    v_mfma_f32_32x32x16_bf16 v[32:47], v[224:227], v[192:195], v[32:47]
    ds_read_b64_tr_b16 v[162:163], v124 offset:768
    ds_read_b64_tr_b16 v[176:177], v124 offset:64
    ds_read_b64_tr_b16 v[178:179], v124 offset:832
    v_mfma_f32_32x32x16_bf16 v[16:31], v[212:215], v[196:199], v[16:31]
    ds_read_b128 v[148:151], v121 offset:0
    ds_read_b64_tr_b16 v[164:165], v125 offset:0
    v_mfma_f32_32x32x16_bf16 v[32:47], v[228:231], v[196:199], v[32:47]
    ds_read_b64_tr_b16 v[166:167], v125 offset:768
    ds_read_b64_tr_b16 v[180:181], v125 offset:64
    ds_read_b64_tr_b16 v[182:183], v125 offset:832
    v_mfma_f32_32x32x16_bf16 v[16:31], v[216:219], v[200:203], v[16:31]
    ds_read_b128 v[152:155], v122 offset:0
    ds_read_b64_tr_b16 v[168:169], v126 offset:0
    v_mfma_f32_32x32x16_bf16 v[32:47], v[232:235], v[200:203], v[32:47]
    ds_read_b64_tr_b16 v[170:171], v126 offset:768
    ds_read_b64_tr_b16 v[184:185], v126 offset:64
    ds_read_b64_tr_b16 v[186:187], v126 offset:832
    v_mfma_f32_32x32x16_bf16 v[16:31], v[220:223], v[204:207], v[16:31]
    ds_read_b128 v[156:159], v123 offset:0
    ds_read_b64_tr_b16 v[172:173], v127 offset:0
    v_mfma_f32_32x32x16_bf16 v[32:47], v[236:239], v[204:207], v[32:47]
    ds_read_b64_tr_b16 v[174:175], v127 offset:768
    ds_read_b64_tr_b16 v[188:189], v127 offset:64
    ds_read_b64_tr_b16 v[190:191], v127 offset:832
    buffer_load_dwordx4 v[96:99], v107, s[52:55], 0 offen sc1
    s_waitcnt lgkmcnt(0)
    s_barrier
    v_dot2c_f32_bf16 v108, s96, v160
    v_dot2c_f32_bf16 v108, s96, v161
    v_dot2c_f32_bf16 v108, s96, v162
    v_dot2c_f32_bf16 v108, s96, v163
    v_dot2c_f32_bf16 v109, s96, v176
    v_dot2c_f32_bf16 v109, s96, v177
    v_dot2c_f32_bf16 v109, s96, v178
    v_dot2c_f32_bf16 v109, s96, v179
    v_mfma_f32_32x32x16_bf16 v[16:31], v[160:163], v[144:147], v[16:31]
    ds_read_b128 v[192:195], v120 offset:16384
    ds_read_b64_tr_b16 v[208:209], v124 offset:12288
    v_mfma_f32_32x32x16_bf16 v[32:47], v[176:179], v[144:147], v[32:47]
    ds_read_b64_tr_b16 v[210:211], v124 offset:13056
    ds_read_b64_tr_b16 v[224:225], v124 offset:12352
    ds_read_b64_tr_b16 v[226:227], v124 offset:13120
    v_mfma_f32_32x32x16_bf16 v[16:31], v[164:167], v[148:151], v[16:31]
    ds_read_b128 v[196:199], v121 offset:16384
    ds_read_b64_tr_b16 v[212:213], v125 offset:12288
    v_mfma_f32_32x32x16_bf16 v[32:47], v[180:183], v[148:151], v[32:47]
    ds_read_b64_tr_b16 v[214:215], v125 offset:13056
    ds_read_b64_tr_b16 v[228:229], v125 offset:12352
    ds_read_b64_tr_b16 v[230:231], v125 offset:13120
    v_mfma_f32_32x32x16_bf16 v[16:31], v[168:171], v[152:155], v[16:31]
    ds_read_b128 v[200:203], v122 offset:16384
    ds_read_b64_tr_b16 v[216:217], v126 offset:12288
    v_mfma_f32_32x32x16_bf16 v[32:47], v[184:187], v[152:155], v[32:47]
    ds_read_b64_tr_b16 v[218:219], v126 offset:13056
    ds_read_b64_tr_b16 v[232:233], v126 offset:12352
    ds_read_b64_tr_b16 v[234:235], v126 offset:13120
    v_mfma_f32_32x32x16_bf16 v[16:31], v[172:175], v[156:159], v[16:31]
    ds_read_b128 v[204:207], v123 offset:16384
    ds_read_b64_tr_b16 v[220:221], v127 offset:12288
    v_mfma_f32_32x32x16_bf16 v[32:47], v[188:191], v[156:159], v[32:47]
    ds_read_b64_tr_b16 v[222:223], v127 offset:13056
    ds_read_b64_tr_b16 v[236:237], v127 offset:12352
    ds_read_b64_tr_b16 v[238:239], v127 offset:13120
    s_waitcnt lgkmcnt(0)
    s_barrier
    v_dot2c_f32_bf16 v108, s96, v208
    v_dot2c_f32_bf16 v108, s96, v209
    v_dot2c_f32_bf16 v108, s96, v210
    v_dot2c_f32_bf16 v108, s96, v211
    v_dot2c_f32_bf16 v109, s96, v224
    v_dot2c_f32_bf16 v109, s96, v225
    v_dot2c_f32_bf16 v109, s96, v226
    v_dot2c_f32_bf16 v109, s96, v227
    v_mfma_f32_32x32x16_bf16 v[16:31], v[208:211], v[192:195], v[16:31]
    ds_read_b128 v[144:147], v120 offset:32768
    ds_read_b64_tr_b16 v[160:161], v124 offset:24576
    v_mfma_f32_32x32x16_bf16 v[32:47], v[224:227], v[192:195], v[32:47]
    ds_read_b64_tr_b16 v[162:163], v124 offset:25344
    ds_read_b64_tr_b16 v[176:177], v124 offset:24640
    ds_read_b64_tr_b16 v[178:179], v124 offset:25408
    v_mfma_f32_32x32x16_bf16 v[16:31], v[212:215], v[196:199], v[16:31]
    ds_read_b128 v[148:151], v121 offset:32768
    ds_read_b64_tr_b16 v[164:165], v125 offset:24576
    v_mfma_f32_32x32x16_bf16 v[32:47], v[228:231], v[196:199], v[32:47]
    ds_read_b64_tr_b16 v[166:167], v125 offset:25344
    ds_read_b64_tr_b16 v[180:181], v125 offset:24640
    ds_read_b64_tr_b16 v[182:183], v125 offset:25408
    v_mfma_f32_32x32x16_bf16 v[16:31], v[216:219], v[200:203], v[16:31]
    ds_read_b128 v[152:155], v122 offset:32768
    ds_read_b64_tr_b16 v[168:169], v126 offset:24576
    ds_read_b64_tr_b16 v[170:171], v126 offset:25344
    v_mfma_f32_32x32x16_bf16 v[32:47], v[232:235], v[200:203], v[32:47]
    ds_read_b64_tr_b16 v[184:185], v126 offset:24640
    ds_read_b64_tr_b16 v[186:187], v126 offset:25408
    v_mfma_f32_32x32x16_bf16 v[16:31], v[220:223], v[204:207], v[16:31]
    ds_read_b128 v[156:159], v123 offset:32768
    ds_read_b64_tr_b16 v[172:173], v127 offset:24576
    ds_read_b64_tr_b16 v[174:175], v127 offset:25344
    v_mfma_f32_32x32x16_bf16 v[32:47], v[236:239], v[204:207], v[32:47]
    ds_read_b64_tr_b16 v[188:189], v127 offset:24640
    ds_read_b64_tr_b16 v[190:191], v127 offset:25408
    ds_read_b64 v[142:143], v94
    s_waitcnt lgkmcnt(0)
    v_readfirstlane_b32 s0, v142
    v_readfirstlane_b32 s1, v143
    v_dot2c_f32_bf16 v108, s96, v160
    v_dot2c_f32_bf16 v108, s96, v161
    v_dot2c_f32_bf16 v108, s96, v162
    v_dot2c_f32_bf16 v108, s96, v163
    v_dot2c_f32_bf16 v109, s96, v176
    v_dot2c_f32_bf16 v109, s96, v177
    v_dot2c_f32_bf16 v109, s96, v178
    v_dot2c_f32_bf16 v109, s96, v179
    v_mfma_f32_32x32x16_bf16 v[16:31], v[160:163], v[144:147], v[16:31]
    ds_write_b32 v91, v108 offset:0
    s_nop 0
    ds_write_b32 v91, v109 offset:1024
    v_mfma_f32_32x32x16_bf16 v[32:47], v[176:179], v[144:147], v[32:47]
    s_waitcnt vmcnt(0)
    s_mov_b32 s22, 200000
    s_and_b32 s5, s1, 0xffff
    s_nop 15
SVL_9:
    v_lshrrev_b32 v14, 16, v97
    v_xor_b32 v14, s5, v14
    v_xor_b32 v15, s0, v99
    v_or_b32 v14, v14, v15
    v_cmp_ne_u32 vcc, 0, v14
    s_sub_u32 s22, s22, 1
    s_cbranch_scc1 SVD_10
    s_nop 2
    s_cbranch_vccz SVD_10
    s_sleep 2
    buffer_load_dwordx4 v[96:99], v107, s[52:55], 0 offen sc1
    s_waitcnt vmcnt(0)
    s_branch SVL_9
SVD_10:
    v_mov_b32 v132, v96
    v_and_b32 v133, 0xffff, v97
    v_mov_b32 v140, v98
    v_mul_f32 v141, 0x3e8b97f6, v98
    s_waitcnt lgkmcnt(0)
    s_barrier
    ds_read2_b32 v[240:241], v92 offset0:0 offset1:32
    ds_read2_b32 v[242:243], v92 offset0:64 offset1:96
    ds_read2_b32 v[244:245], v92 offset0:128 offset1:160
    ds_read2_b32 v[246:247], v92 offset0:192 offset1:224
    ds_read2_b32 v[248:249], v93 offset0:0 offset1:32
    ds_read2_b32 v[250:251], v93 offset0:64 offset1:96
    ds_read2_b32 v[252:253], v93 offset0:128 offset1:160
    ds_read2_b32 v[254:255], v93 offset0:192 offset1:224
    s_cmp_eq_u32 s100, 1
    s_cselect_b64 s[18:19], -1, 0
    v_cndmask_b32 v128, v140, v141, s[18:19]
    v_cndmask_b32 v129, v140, v141, s[18:19]
    s_cmp_eq_u32 s101, 1
    s_cselect_b64 s[18:19], -1, 0
    v_cndmask_b32 v130, v140, v141, s[18:19]
    v_cndmask_b32 v131, v140, v141, s[18:19]
    v_mfma_f32_32x32x16_bf16 v[16:31], v[164:167], v[148:151], v[16:31]
    v_mfma_f32_32x32x16_bf16 v[32:47], v[180:183], v[148:151], v[32:47]
    v_mfma_f32_32x32x16_bf16 v[16:31], v[168:171], v[152:155], v[16:31]
    v_mfma_f32_32x32x16_bf16 v[32:47], v[184:187], v[152:155], v[32:47]
    v_mfma_f32_32x32x16_bf16 v[16:31], v[172:175], v[156:159], v[16:31]
    v_mfma_f32_32x32x16_bf16 v[32:47], v[188:191], v[156:159], v[32:47]
    s_waitcnt lgkmcnt(4)
    v_pk_add_f32 v[240:241], v[240:241], v[242:243]
    v_pk_add_f32 v[244:245], v[244:245], v[246:247]
    v_pk_add_f32 v[240:241], v[240:241], v[244:245]
    v_add_f32 v240, v240, v241
    v_cndmask_b32 v240, v240, 0, s[20:21]
    v_cvt_pk_bf16_f32 v113, v240, 0
    v_lshlrev_b32 v114, 16, v113
    v_sub_f32 v114, v240, v114
    v_cvt_pk_bf16_f32 v112, v240, v114
    v_mov_b32 v114, 0
    v_mov_b32 v115, 0
    s_nop 1
    v_mfma_f32_32x32x16_bf16 v[16:31], v[112:115], v[132:135], v[16:31]
    s_waitcnt lgkmcnt(0)
    v_pk_add_f32 v[248:249], v[248:249], v[250:251]
    v_pk_add_f32 v[252:253], v[252:253], v[254:255]
    v_pk_add_f32 v[248:249], v[248:249], v[252:253]
    v_add_f32 v248, v248, v249
    v_cndmask_b32 v248, v248, 0, s[20:21]
    v_cvt_pk_bf16_f32 v117, v248, 0
    v_lshlrev_b32 v118, 16, v117
    v_sub_f32 v118, v248, v118
    v_cvt_pk_bf16_f32 v116, v248, v118
    v_mov_b32 v118, 0
    v_mov_b32 v119, 0
    s_nop 1
    v_mfma_f32_32x32x16_bf16 v[32:47], v[116:119], v[132:135], v[32:47]
    v_pk_mul_f32 v[16:17], v[16:17], v[128:129]
    v_pk_mul_f32 v[18:19], v[18:19], v[128:129]
    v_pk_mul_f32 v[20:21], v[20:21], v[128:129]
    v_pk_mul_f32 v[22:23], v[22:23], v[128:129]
    v_cvt_pk_bf16_f32 v240, v16, v17
    v_cvt_pk_bf16_f32 v241, v18, v19
    v_cvt_pk_bf16_f32 v242, v20, v21
    v_cvt_pk_bf16_f32 v243, v22, v23
    v_pk_mul_f32 v[24:25], v[24:25], v[128:129]
    v_pk_mul_f32 v[26:27], v[26:27], v[128:129]
    v_pk_mul_f32 v[28:29], v[28:29], v[128:129]
    v_pk_mul_f32 v[30:31], v[30:31], v[128:129]
    v_cvt_pk_bf16_f32 v244, v24, v25
    v_cvt_pk_bf16_f32 v245, v26, v27
    v_cvt_pk_bf16_f32 v246, v28, v29
    v_cvt_pk_bf16_f32 v247, v30, v31
    v_permlane32_swap_b32 v240, v242
    v_permlane32_swap_b32 v241, v243
    buffer_store_dwordx4 v[240:243], v136, s[52:55], 0 offen offset:0 sc1
    v_permlane32_swap_b32 v244, v246
    v_permlane32_swap_b32 v245, v247
    buffer_store_dwordx4 v[244:247], v136, s[52:55], 0 offen offset:1024 sc1
    v_pk_mul_f32 v[32:33], v[32:33], v[130:131]
    v_pk_mul_f32 v[34:35], v[34:35], v[130:131]
    v_pk_mul_f32 v[36:37], v[36:37], v[130:131]
    v_pk_mul_f32 v[38:39], v[38:39], v[130:131]
    v_cvt_pk_bf16_f32 v248, v32, v33
    v_cvt_pk_bf16_f32 v249, v34, v35
    v_cvt_pk_bf16_f32 v250, v36, v37
    v_cvt_pk_bf16_f32 v251, v38, v39
    v_pk_mul_f32 v[40:41], v[40:41], v[130:131]
    v_pk_mul_f32 v[42:43], v[42:43], v[130:131]
    v_pk_mul_f32 v[44:45], v[44:45], v[130:131]
    v_pk_mul_f32 v[46:47], v[46:47], v[130:131]
    v_cvt_pk_bf16_f32 v252, v40, v41
    v_cvt_pk_bf16_f32 v253, v42, v43
    v_cvt_pk_bf16_f32 v254, v44, v45
    v_cvt_pk_bf16_f32 v255, v46, v47
    v_permlane32_swap_b32 v248, v250
    v_permlane32_swap_b32 v249, v251
    buffer_store_dwordx4 v[248:251], v137, s[52:55], 0 offen offset:0 sc1
    v_permlane32_swap_b32 v252, v254
    v_permlane32_swap_b32 v253, v255
    buffer_store_dwordx4 v[252:255], v137, s[52:55], 0 offen offset:1024 sc1
    s_branch P1J_4
P1R1_3:
    s_and_b32 s3, s94, 3
    s_lshl_b32 s3, s3, 1
    s_add_u32 s3, s3, s23
    s_sub_u32 s4, s3, 7
    s_cmp_ge_u32 s3, 7
    s_cselect_b32 s3, s4, s3
    s_mul_i32 s4, s3, 64
    s_lshr_b32 s4, s4, 8
    s_mul_i32 s4, s4, 4
    s_sub_u32 s3, s3, s4
    s_lshl_b32 s64, s3, 7
    s_lshl_b32 s3, s94, 7
    s_lshl_b32 s4, s59, 5
    s_add_u32 s3, s3, s4
    v_lshrrev_b32 v14, 3, v1
    v_add_u32 v14, s3, v14
    v_mul_u32_u24 v14, 896, v14
    v_lshrrev_b32 v15, 4, v1
    v_xor_b32 v15, v15, v1
    v_and_b32 v15, 7, v15
    v_lshl_add_u32 v100, v15, 4, v14
    v_xor_b32 v15, 4, v15
    v_lshl_add_u32 v101, v15, 4, v14
    v_add_u32 v102, 12288, v100
    v_add_u32 v103, 18432, v101
    v_add_u32 v101, 6144, v101
    s_lshl_b32 s7, s59, 12
    s_waitcnt lgkmcnt(0)
    s_mov_b32 s24, s72
    s_and_b32 s25, s73, 0xffff
    s_mov_b32 s26, 1835008
    s_mov_b32 s27, 0x20000
    s_mov_b32 s28, s74
    s_and_b32 s29, s75, 0xffff
    s_mov_b32 s30, 1204224
    s_mov_b32 s31, 0x20000
    s_add_u32 m0, s7, 0
    s_nop 0
    buffer_load_dwordx4 v100, s[24:27], s64 offen lds
    buffer_load_dwordx4 v101, s[24:27], s64 offen offset:1024 lds
    buffer_load_dwordx4 v102, s[24:27], s64 offen offset:2048 lds
    buffer_load_dwordx4 v103, s[24:27], s64 offen offset:3072 lds
    s_add_u32 s65, s64, 128
    s_cmp_eq_u32 s65, 512
    s_cselect_b32 s65, 0, s65
    s_add_u32 m0, s7, 16384
    s_nop 0
    buffer_load_dwordx4 v100, s[24:27], s65 offen lds
    buffer_load_dwordx4 v101, s[24:27], s65 offen offset:1024 lds
    buffer_load_dwordx4 v102, s[24:27], s65 offen offset:2048 lds
    buffer_load_dwordx4 v103, s[24:27], s65 offen offset:3072 lds
    s_mov_b32 s32, s76
    s_and_b32 s33, s77, 0xffff
    s_mov_b32 s34, 401408
    s_mov_b32 s35, 0x20000
    s_mov_b32 s36, s80
    s_and_b32 s37, s81, 0xffff
    s_mov_b32 s38, 1605632
    s_mov_b32 s39, 0x20000
    s_mov_b32 s40, s82
    s_and_b32 s41, s83, 0xffff
    s_mov_b32 s42, 1605632
    s_mov_b32 s43, 0x20000
    s_mov_b32 s44, s84
    s_and_b32 s45, s85, 0xffff
    s_mov_b32 s46, 1835008
    s_mov_b32 s47, 0x20000
    s_mov_b32 s48, s86
    s_and_b32 s49, s87, 0xffff
    s_mov_b32 s50, 256
    s_mov_b32 s51, 0x20000
    s_mov_b32 s52, s88
    s_and_b32 s53, s89, 0xffff
    s_mov_b32 s54, 41943040
    s_mov_b32 s55, 0x20000
    v_and_b32 v14, 31, v1
    v_bfe_u32 v15, v1, 1, 3
    v_lshrrev_b32 v120, 5, v1
    v_xor_b32 v15, v15, v120
    s_lshl_b32 s4, s59, 12
    v_lshl_add_u32 v14, v14, 7, s4
    s_add_u32 s3, s59, 0
    s_and_b32 s3, s3, 3
    s_lshl_b32 s4, s3, 1
    s_mul_i32 s10, s3, 3072
    v_xor_b32 v120, s4, v15
    v_lshl_add_u32 v120, v120, 4, v14
    s_add_u32 s3, s59, 1
    s_and_b32 s3, s3, 3
    s_lshl_b32 s4, s3, 1
    s_mul_i32 s11, s3, 3072
    v_xor_b32 v121, s4, v15
    v_lshl_add_u32 v121, v121, 4, v14
    s_add_u32 s3, s59, 2
    s_and_b32 s3, s3, 3
    s_lshl_b32 s4, s3, 1
    s_mul_i32 s12, s3, 3072
    v_xor_b32 v122, s4, v15
    v_lshl_add_u32 v122, v122, 4, v14
    s_add_u32 s3, s59, 3
    s_and_b32 s3, s3, 3
    s_lshl_b32 s4, s3, 1
    s_mul_i32 s13, s3, 3072
    v_xor_b32 v123, s4, v15
    v_lshl_add_u32 v123, v123, 4, v14
    v_lshrrev_b32 v14, 5, v1
    v_bfe_u32 v15, v1, 2, 2
    v_lshl_add_u32 v14, v14, 3, v15
    v_mul_u32_u24 v14, 192, v14
    v_bfe_u32 v15, v1, 4, 1
    v_lshl_add_u32 v14, v15, 5, v14
    v_and_b32 v15, 3, v1
    v_lshl_add_u32 v14, v15, 3, v14
    v_add_u32 v14, 65664, v14
    v_add_u32 v124, s10, v14
    v_add_u32 v125, s11, v14
    v_add_u32 v126, s12, v14
    v_add_u32 v127, s13, v14
    v_mov_b32 v108, 0
    v_mov_b32 v109, 0
    v_mov_b32 v134, 0
    v_mov_b32 v135, 0
    s_mul_i32 s3, s59, 43008
    s_mul_i32 s4, s95, 192
    s_add_u32 s3, s3, s4
    v_add_u32 v14, 0, v1
    v_mul_u32_u24 v15, 43691, v14
    v_lshrrev_b32 v15, 19, v15
    v_mul_u32_u24 v15, 2496, v15
    v_lshl_add_u32 v15, v1, 4, v15
    v_add_u32 v104, s3, v15
    v_add_u32 v14, 64, v1
    v_mul_u32_u24 v15, 43691, v14
    v_lshrrev_b32 v15, 19, v15
    v_mul_u32_u24 v15, 2496, v15
    v_lshl_add_u32 v15, v1, 4, v15
    v_add_u32 v105, s3, v15
    v_add_u32 v14, 128, v1
    v_mul_u32_u24 v15, 43691, v14
    v_lshrrev_b32 v15, 19, v15
    v_mul_u32_u24 v15, 2496, v15
    v_lshl_add_u32 v15, v1, 4, v15
    v_add_u32 v106, s3, v15
    s_mul_i32 s8, s59, 3072
    s_add_u32 s66, s65, 128
    s_cmp_eq_u32 s66, 512
    s_cselect_b32 s66, 0, s66
    s_add_u32 s67, s66, 128
    s_cmp_eq_u32 s67, 512
    s_cselect_b32 s67, 0, s67
    s_add_u32 s68, s64, 512
    s_cmp_ge_u32 s68, 896
    s_cselect_b32 s68, 512, s68
    s_add_u32 s69, s68, 128
    s_cmp_eq_u32 s69, 896
    s_cselect_b32 s69, 512, s69
    s_add_u32 s70, s69, 128
    s_cmp_eq_u32 s70, 896
    s_cselect_b32 s70, 512, s70
    s_mul_i32 s3, s95, 3
    s_add_u32 s3, s3, 2
    s_cmp_lt_u32 s3, 14
    s_cselect_b32 s100, 1, 0
    s_lshl_b32 s3, s3, 6
    s_lshl_b32 s4, s94, 2
    s_add_u32 s3, s3, s4
    s_add_u32 s3, s3, s59
    s_lshl_b32 s3, s3, 11
    v_lshl_add_u32 v136, v1, 4, s3
    s_lshl_b32 s3, s59, 3
    s_lshl_b32 s5, s23, 7
    v_lshrrev_b32 v14, 3, v1
    v_bfe_u32 v15, v1, 4, 1
    v_lshlrev_b32 v15, 2, v15
    v_xor_b32 v15, v15, v1
    v_and_b32 v15, 7, v15
    v_add_u32 v14, s3, v14
    v_mul_u32_u24 v14, 896, v14
    v_lshl_add_u32 v14, v15, 4, v14
    v_add_u32 v138, s5, v14
    s_lshl_b32 s3, s56, 7
    s_lshl_b32 s4, s97, 6
    s_add_u32 s3, s3, s4
    s_mul_i32 s3, s3, 896
    v_add_u32 v139, s3, v138
    s_lshl_b32 s9, s59, 10
    s_lshl_b32 s3, s59, 9
    s_lshl_b32 s4, s94, 11
    s_add_u32 s3, s3, s4
    s_add_u32 s3, s3, 11534336
    v_mov_b32 v94, 163344
    v_and_b32 v14, 31, v1
    v_lshl_add_u32 v107, v14, 4, s3
    v_lshlrev_b32 v91, 2, v0
    v_add_u32 v91, 154624, v91
    v_lshlrev_b32 v92, 2, v14
    v_add_u32 v92, 155648, v92
    v_add_u32 v93, 1024, v92
    s_waitcnt vmcnt(4) lgkmcnt(0)
    s_barrier
    ds_read_b128 v[144:147], v120 offset:0
    ds_read_b64_tr_b16 v[160:161], v124 offset:0
    ds_read_b64_tr_b16 v[162:163], v124 offset:768
    ds_read_b128 v[148:151], v121 offset:0
    ds_read_b64_tr_b16 v[164:165], v125 offset:0
    ds_read_b64_tr_b16 v[166:167], v125 offset:768
    ds_read_b128 v[152:155], v122 offset:0
    ds_read_b64_tr_b16 v[168:169], v126 offset:0
    ds_read_b64_tr_b16 v[170:171], v126 offset:768
    ds_read_b128 v[156:159], v123 offset:0
    ds_read_b64_tr_b16 v[172:173], v127 offset:0
    ds_read_b64_tr_b16 v[174:175], v127 offset:768
    s_add_u32 m0, s7, 32768
    s_nop 0
    buffer_load_dwordx4 v100, s[24:27], s66 offen lds
    buffer_load_dwordx4 v101, s[24:27], s66 offen offset:1024 lds
    buffer_load_dwordx4 v102, s[24:27], s66 offen offset:2048 lds
    buffer_load_dwordx4 v103, s[24:27], s66 offen offset:3072 lds
    s_mul_i32 s4, s66, 1344
    s_add_u32 m0, s8, 90112
    s_nop 0
    buffer_load_dwordx4 v104, s[28:31], s4 offen lds
    buffer_load_dwordx4 v105, s[28:31], s4 offen offset:1024 lds
    buffer_load_dwordx4 v106, s[28:31], s4 offen offset:2048 lds
    s_waitcnt vmcnt(7) lgkmcnt(0)
    s_barrier
    ds_read_b128 v[192:195], v120 offset:16384
    ds_read_b64_tr_b16 v[208:209], v124 offset:12288
    ds_read_b64_tr_b16 v[210:211], v124 offset:13056
    ds_read_b128 v[196:199], v121 offset:16384
    ds_read_b64_tr_b16 v[212:213], v125 offset:12288
    ds_read_b64_tr_b16 v[214:215], v125 offset:13056
    ds_read_b128 v[200:203], v122 offset:16384
    ds_read_b64_tr_b16 v[216:217], v126 offset:12288
    ds_read_b64_tr_b16 v[218:219], v126 offset:13056
    ds_read_b128 v[204:207], v123 offset:16384
    ds_read_b64_tr_b16 v[220:221], v127 offset:12288
    ds_read_b64_tr_b16 v[222:223], v127 offset:13056
    s_add_u32 m0, s7, 49152
    s_nop 0
    buffer_load_dwordx4 v100, s[24:27], s67 offen lds
    buffer_load_dwordx4 v101, s[24:27], s67 offen offset:1024 lds
    buffer_load_dwordx4 v102, s[24:27], s67 offen offset:2048 lds
    buffer_load_dwordx4 v103, s[24:27], s67 offen offset:3072 lds
    s_mul_i32 s4, s67, 1344
    s_add_u32 m0, s8, 102400
    s_nop 0
    buffer_load_dwordx4 v104, s[28:31], s4 offen lds
    buffer_load_dwordx4 v105, s[28:31], s4 offen offset:1024 lds
    buffer_load_dwordx4 v106, s[28:31], s4 offen offset:2048 lds
    v_dot2c_f32_bf16 v108, s96, v160
    v_dot2c_f32_bf16 v108, s96, v161
    v_dot2c_f32_bf16 v108, s96, v162
    v_dot2c_f32_bf16 v108, s96, v163
    v_mfma_f32_32x32x16_bf16 v[16:31], v[160:163], v[144:147], 0
    v_mfma_f32_32x32x16_bf16 v[16:31], v[164:167], v[148:151], v[16:31]
    v_mfma_f32_32x32x16_bf16 v[16:31], v[168:171], v[152:155], v[16:31]
    v_mfma_f32_32x32x16_bf16 v[16:31], v[172:175], v[156:159], v[16:31]
    s_waitcnt vmcnt(7) lgkmcnt(0)
    s_barrier
    ds_read_b128 v[144:147], v120 offset:32768
    ds_read_b64_tr_b16 v[160:161], v124 offset:24576
    ds_read_b64_tr_b16 v[162:163], v124 offset:25344
    ds_read_b128 v[148:151], v121 offset:32768
    ds_read_b64_tr_b16 v[164:165], v125 offset:24576
    ds_read_b64_tr_b16 v[166:167], v125 offset:25344
    ds_read_b128 v[152:155], v122 offset:32768
    ds_read_b64_tr_b16 v[168:169], v126 offset:24576
    ds_read_b64_tr_b16 v[170:171], v126 offset:25344
    ds_read_b128 v[156:159], v123 offset:32768
    ds_read_b64_tr_b16 v[172:173], v127 offset:24576
    ds_read_b64_tr_b16 v[174:175], v127 offset:25344
    s_add_u32 m0, s7, 0
    s_nop 0
    buffer_load_dwordx4 v100, s[24:27], s68 offen lds
    buffer_load_dwordx4 v101, s[24:27], s68 offen offset:1024 lds
    buffer_load_dwordx4 v102, s[24:27], s68 offen offset:2048 lds
    buffer_load_dwordx4 v103, s[24:27], s68 offen offset:3072 lds
    s_mul_i32 s4, s68, 1344
    s_add_u32 m0, s8, 114688
    s_nop 0
    buffer_load_dwordx4 v104, s[28:31], s4 offen lds
    buffer_load_dwordx4 v105, s[28:31], s4 offen offset:1024 lds
    buffer_load_dwordx4 v106, s[28:31], s4 offen offset:2048 lds
    v_dot2c_f32_bf16 v108, s96, v208
    v_dot2c_f32_bf16 v108, s96, v209
    v_dot2c_f32_bf16 v108, s96, v210
    v_dot2c_f32_bf16 v108, s96, v211
    v_mfma_f32_32x32x16_bf16 v[16:31], v[208:211], v[192:195], v[16:31]
    v_mfma_f32_32x32x16_bf16 v[16:31], v[212:215], v[196:199], v[16:31]
    v_mfma_f32_32x32x16_bf16 v[16:31], v[216:219], v[200:203], v[16:31]
    v_mfma_f32_32x32x16_bf16 v[16:31], v[220:223], v[204:207], v[16:31]
    s_waitcnt vmcnt(7) lgkmcnt(0)
    s_barrier
    ds_read_b128 v[192:195], v120 offset:49152
    ds_read_b64_tr_b16 v[208:209], v124 offset:36864
    ds_read_b64_tr_b16 v[210:211], v124 offset:37632
    ds_read_b128 v[196:199], v121 offset:49152
    ds_read_b64_tr_b16 v[212:213], v125 offset:36864
    ds_read_b64_tr_b16 v[214:215], v125 offset:37632
    ds_read_b128 v[200:203], v122 offset:49152
    ds_read_b64_tr_b16 v[216:217], v126 offset:36864
    ds_read_b64_tr_b16 v[218:219], v126 offset:37632
    ds_read_b128 v[204:207], v123 offset:49152
    ds_read_b64_tr_b16 v[220:221], v127 offset:36864
    ds_read_b64_tr_b16 v[222:223], v127 offset:37632
    s_add_u32 m0, s7, 16384
    s_nop 0
    buffer_load_dwordx4 v100, s[24:27], s69 offen lds
    buffer_load_dwordx4 v101, s[24:27], s69 offen offset:1024 lds
    buffer_load_dwordx4 v102, s[24:27], s69 offen offset:2048 lds
    buffer_load_dwordx4 v103, s[24:27], s69 offen offset:3072 lds
    s_mul_i32 s4, s69, 1344
    s_add_u32 m0, s8, 126976
    s_nop 0
    buffer_load_dwordx4 v104, s[28:31], s4 offen lds
    buffer_load_dwordx4 v105, s[28:31], s4 offen offset:1024 lds
    buffer_load_dwordx4 v106, s[28:31], s4 offen offset:2048 lds
    v_dot2c_f32_bf16 v108, s96, v160
    v_dot2c_f32_bf16 v108, s96, v161
    v_dot2c_f32_bf16 v108, s96, v162
    v_dot2c_f32_bf16 v108, s96, v163
    v_mfma_f32_32x32x16_bf16 v[16:31], v[160:163], v[144:147], v[16:31]
    v_mfma_f32_32x32x16_bf16 v[16:31], v[164:167], v[148:151], v[16:31]
    v_mfma_f32_32x32x16_bf16 v[16:31], v[168:171], v[152:155], v[16:31]
    v_mfma_f32_32x32x16_bf16 v[16:31], v[172:175], v[156:159], v[16:31]
    s_waitcnt vmcnt(7) lgkmcnt(0)
    s_barrier
    v_add_u32 v124, 49152, v124
    v_add_u32 v125, 49152, v125
    v_add_u32 v126, 49152, v126
    v_add_u32 v127, 49152, v127
    ds_read_b128 v[144:147], v120 offset:0
    ds_read_b64_tr_b16 v[160:161], v124 offset:0
    ds_read_b64_tr_b16 v[162:163], v124 offset:768
    ds_read_b128 v[148:151], v121 offset:0
    ds_read_b64_tr_b16 v[164:165], v125 offset:0
    ds_read_b64_tr_b16 v[166:167], v125 offset:768
    ds_read_b128 v[152:155], v122 offset:0
    ds_read_b64_tr_b16 v[168:169], v126 offset:0
    ds_read_b64_tr_b16 v[170:171], v126 offset:768
    ds_read_b128 v[156:159], v123 offset:0
    ds_read_b64_tr_b16 v[172:173], v127 offset:0
    ds_read_b64_tr_b16 v[174:175], v127 offset:768
    s_add_u32 m0, s7, 32768
    s_nop 0
    buffer_load_dwordx4 v100, s[24:27], s70 offen lds
    buffer_load_dwordx4 v101, s[24:27], s70 offen offset:1024 lds
    buffer_load_dwordx4 v102, s[24:27], s70 offen offset:2048 lds
    buffer_load_dwordx4 v103, s[24:27], s70 offen offset:3072 lds
    s_mul_i32 s4, s70, 1344
    s_add_u32 m0, s8, 139264
    s_nop 0
    buffer_load_dwordx4 v104, s[28:31], s4 offen lds
    buffer_load_dwordx4 v105, s[28:31], s4 offen offset:1024 lds
    buffer_load_dwordx4 v106, s[28:31], s4 offen offset:2048 lds
    buffer_load_dwordx4 v[96:99], v107, s[52:55], 0 offen sc1
    v_dot2c_f32_bf16 v108, s96, v208
    v_dot2c_f32_bf16 v108, s96, v209
    v_dot2c_f32_bf16 v108, s96, v210
    v_dot2c_f32_bf16 v108, s96, v211
    v_mfma_f32_32x32x16_bf16 v[16:31], v[208:211], v[192:195], v[16:31]
    v_mfma_f32_32x32x16_bf16 v[16:31], v[212:215], v[196:199], v[16:31]
    v_mfma_f32_32x32x16_bf16 v[16:31], v[216:219], v[200:203], v[16:31]
    v_mfma_f32_32x32x16_bf16 v[16:31], v[220:223], v[204:207], v[16:31]
    s_waitcnt vmcnt(8) lgkmcnt(0)
    s_barrier
    ds_read_b128 v[192:195], v120 offset:16384
    ds_read_b64_tr_b16 v[208:209], v124 offset:12288
    ds_read_b64_tr_b16 v[210:211], v124 offset:13056
    ds_read_b128 v[196:199], v121 offset:16384
    ds_read_b64_tr_b16 v[212:213], v125 offset:12288
    ds_read_b64_tr_b16 v[214:215], v125 offset:13056
    ds_read_b128 v[200:203], v122 offset:16384
    ds_read_b64_tr_b16 v[216:217], v126 offset:12288
    ds_read_b64_tr_b16 v[218:219], v126 offset:13056
    ds_read_b128 v[204:207], v123 offset:16384
    ds_read_b64_tr_b16 v[220:221], v127 offset:12288
    ds_read_b64_tr_b16 v[222:223], v127 offset:13056
    s_mov_b32 s3, 0
    s_add_u32 m0, s9, 65536
    s_nop 0
    buffer_load_dwordx4 v138, s[32:35], s3 offen lds
    s_mov_b32 s3, 28672
    s_add_u32 m0, s9, 69632
    s_nop 0
    buffer_load_dwordx4 v138, s[32:35], s3 offen lds
    s_mov_b32 s3, 57344
    s_add_u32 m0, s9, 73728
    s_nop 0
    buffer_load_dwordx4 v138, s[32:35], s3 offen lds
    s_mov_b32 s3, 86016
    s_add_u32 m0, s9, 77824
    s_nop 0
    buffer_load_dwordx4 v138, s[32:35], s3 offen lds
    s_mov_b32 s3, 114688
    s_add_u32 m0, s9, 81920
    s_nop 0
    buffer_load_dwordx4 v138, s[32:35], s3 offen lds
    s_mov_b32 s3, 143360
    s_add_u32 m0, s9, 86016
    s_nop 0
    buffer_load_dwordx4 v138, s[32:35], s3 offen lds
    s_mov_b32 s3, 172032
    s_add_u32 m0, s9, 90112
    s_nop 0
    buffer_load_dwordx4 v138, s[32:35], s3 offen lds
    s_mov_b32 s3, 200704
    s_add_u32 m0, s9, 94208
    s_nop 0
    buffer_load_dwordx4 v138, s[32:35], s3 offen lds
    v_dot2c_f32_bf16 v108, s96, v160
    v_dot2c_f32_bf16 v108, s96, v161
    v_dot2c_f32_bf16 v108, s96, v162
    v_dot2c_f32_bf16 v108, s96, v163
    v_mfma_f32_32x32x16_bf16 v[16:31], v[160:163], v[144:147], v[16:31]
    v_mfma_f32_32x32x16_bf16 v[16:31], v[164:167], v[148:151], v[16:31]
    v_mfma_f32_32x32x16_bf16 v[16:31], v[168:171], v[152:155], v[16:31]
    v_mfma_f32_32x32x16_bf16 v[16:31], v[172:175], v[156:159], v[16:31]
    s_waitcnt vmcnt(9) lgkmcnt(0)
    s_barrier
    ds_read_b128 v[144:147], v120 offset:32768
    ds_read_b64_tr_b16 v[160:161], v124 offset:24576
    ds_read_b64_tr_b16 v[162:163], v124 offset:25344
    ds_read_b128 v[148:151], v121 offset:32768
    ds_read_b64_tr_b16 v[164:165], v125 offset:24576
    ds_read_b64_tr_b16 v[166:167], v125 offset:25344
    ds_read_b128 v[152:155], v122 offset:32768
    ds_read_b64_tr_b16 v[168:169], v126 offset:24576
    ds_read_b64_tr_b16 v[170:171], v126 offset:25344
    ds_read_b128 v[156:159], v123 offset:32768
    ds_read_b64_tr_b16 v[172:173], v127 offset:24576
    ds_read_b64_tr_b16 v[174:175], v127 offset:25344
    ds_read_b64 v[142:143], v94
    s_mov_b32 s3, 229376
    s_add_u32 m0, s9, 98304
    s_nop 0
    buffer_load_dwordx4 v138, s[32:35], s3 offen lds
    s_mov_b32 s3, 258048
    s_add_u32 m0, s9, 102400
    s_nop 0
    buffer_load_dwordx4 v138, s[32:35], s3 offen lds
    s_mov_b32 s3, 286720
    s_add_u32 m0, s9, 106496
    s_nop 0
    buffer_load_dwordx4 v138, s[32:35], s3 offen lds
    s_mov_b32 s3, 315392
    s_add_u32 m0, s9, 110592
    s_nop 0
    buffer_load_dwordx4 v138, s[32:35], s3 offen lds
    s_mov_b32 s3, 344064
    s_add_u32 m0, s9, 114688
    s_nop 0
    buffer_load_dwordx4 v138, s[32:35], s3 offen lds
    s_mov_b32 s3, 372736
    s_add_u32 m0, s9, 118784
    s_nop 0
    buffer_load_dwordx4 v138, s[32:35], s3 offen lds
    s_mov_b32 s3, 0
    s_add_u32 m0, s9, 122880
    s_nop 0
    buffer_load_dwordx4 v139, s[24:27], s3 offen lds
    s_mov_b32 s3, 28672
    s_add_u32 m0, s9, 126976
    s_nop 0
    buffer_load_dwordx4 v139, s[24:27], s3 offen lds
    v_dot2c_f32_bf16 v108, s96, v208
    v_dot2c_f32_bf16 v108, s96, v209
    v_dot2c_f32_bf16 v108, s96, v210
    v_dot2c_f32_bf16 v108, s96, v211
    v_mfma_f32_32x32x16_bf16 v[16:31], v[208:211], v[192:195], v[16:31]
    v_mfma_f32_32x32x16_bf16 v[16:31], v[212:215], v[196:199], v[16:31]
    v_mfma_f32_32x32x16_bf16 v[16:31], v[216:219], v[200:203], v[16:31]
    v_mfma_f32_32x32x16_bf16 v[16:31], v[220:223], v[204:207], v[16:31]
    s_waitcnt lgkmcnt(0)
    v_readfirstlane_b32 s0, v142
    v_readfirstlane_b32 s1, v143
    v_dot2c_f32_bf16 v108, s96, v160
    v_dot2c_f32_bf16 v108, s96, v161
    v_dot2c_f32_bf16 v108, s96, v162
    v_dot2c_f32_bf16 v108, s96, v163
    v_mfma_f32_32x32x16_bf16 v[16:31], v[160:163], v[144:147], v[16:31]
    s_nop 1
    ds_write_b32 v91, v108 offset:0
    s_waitcnt vmcnt(16)
    s_mov_b32 s22, 200000
    s_and_b32 s5, s1, 0xffff
    s_nop 15
SVL_11:
    v_lshrrev_b32 v14, 16, v97
    v_xor_b32 v14, s5, v14
    v_xor_b32 v15, s0, v99
    v_or_b32 v14, v14, v15
    v_cmp_ne_u32 vcc, 0, v14
    s_sub_u32 s22, s22, 1
    s_cbranch_scc1 SVD_12
    s_nop 2
    s_cbranch_vccz SVD_12
    s_sleep 2
    buffer_load_dwordx4 v[96:99], v107, s[52:55], 0 offen sc1
    s_waitcnt vmcnt(0)
    s_branch SVL_11
SVD_12:
    v_mov_b32 v132, v96
    v_and_b32 v133, 0xffff, v97
    v_mov_b32 v140, v98
    v_mul_f32 v141, 0x3e8b97f6, v98
    s_waitcnt lgkmcnt(0)
    s_barrier
    ds_read2_b32 v[240:241], v92 offset0:0 offset1:32
    ds_read2_b32 v[242:243], v92 offset0:64 offset1:96
    ds_read2_b32 v[244:245], v92 offset0:128 offset1:160
    ds_read2_b32 v[246:247], v92 offset0:192 offset1:224
    s_cmp_eq_u32 s100, 1
    s_cselect_b64 s[18:19], -1, 0
    v_cndmask_b32 v128, v140, v141, s[18:19]
    v_cndmask_b32 v129, v140, v141, s[18:19]
    v_mfma_f32_32x32x16_bf16 v[16:31], v[164:167], v[148:151], v[16:31]
    v_mfma_f32_32x32x16_bf16 v[16:31], v[168:171], v[152:155], v[16:31]
    v_mfma_f32_32x32x16_bf16 v[16:31], v[172:175], v[156:159], v[16:31]
    s_waitcnt lgkmcnt(0)
    v_pk_add_f32 v[240:241], v[240:241], v[242:243]
    v_pk_add_f32 v[244:245], v[244:245], v[246:247]
    v_pk_add_f32 v[240:241], v[240:241], v[244:245]
    v_add_f32 v240, v240, v241
    v_cndmask_b32 v240, v240, 0, s[20:21]
    v_cvt_pk_bf16_f32 v113, v240, 0
    v_lshlrev_b32 v114, 16, v113
    v_sub_f32 v114, v240, v114
    v_cvt_pk_bf16_f32 v112, v240, v114
    v_mov_b32 v114, 0
    v_mov_b32 v115, 0
    s_nop 1
    v_mfma_f32_32x32x16_bf16 v[16:31], v[112:115], v[132:135], v[16:31]
    s_nop 11
    v_pk_mul_f32 v[16:17], v[16:17], v[128:129]
    v_pk_mul_f32 v[18:19], v[18:19], v[128:129]
    v_pk_mul_f32 v[20:21], v[20:21], v[128:129]
    v_pk_mul_f32 v[22:23], v[22:23], v[128:129]
    v_cvt_pk_bf16_f32 v240, v16, v17
    v_cvt_pk_bf16_f32 v241, v18, v19
    v_cvt_pk_bf16_f32 v242, v20, v21
    v_cvt_pk_bf16_f32 v243, v22, v23
    v_pk_mul_f32 v[24:25], v[24:25], v[128:129]
    v_pk_mul_f32 v[26:27], v[26:27], v[128:129]
    v_pk_mul_f32 v[28:29], v[28:29], v[128:129]
    v_pk_mul_f32 v[30:31], v[30:31], v[128:129]
    v_cvt_pk_bf16_f32 v244, v24, v25
    v_cvt_pk_bf16_f32 v245, v26, v27
    v_cvt_pk_bf16_f32 v246, v28, v29
    v_cvt_pk_bf16_f32 v247, v30, v31
    v_permlane32_swap_b32 v240, v242
    v_permlane32_swap_b32 v241, v243
    buffer_store_dwordx4 v[240:243], v136, s[52:55], 0 offen offset:0 sc1
    v_permlane32_swap_b32 v244, v246
    v_permlane32_swap_b32 v245, v247
    buffer_store_dwordx4 v[244:247], v136, s[52:55], 0 offen offset:1024 sc1
    s_and_b32 s4, s58, 1
    s_lshl_b32 s3, s60, 1
    s_add_u32 s3, s3, s4
    s_mul_i32 s3, s3, 14336
    s_add_u32 s3, s3, 65536
    s_mov_b32 s100, 0
    v_lshrrev_b32 v14, 5, v1
    v_lshlrev_b32 v14, 10, v14
    v_bfe_u32 v15, v1, 2, 2
    v_lshl_add_u32 v14, v15, 7, v14
    v_bfe_u32 v15, v1, 4, 1
    v_lshl_add_u32 v14, v15, 5, v14
    v_and_b32 v15, 3, v1
    v_lshl_add_u32 v14, v15, 3, v14
    v_bfe_u32 v15, v1, 3, 1
    v_lshlrev_b32 v15, 6, v15
    v_xor_b32 v15, s100, v15
    v_add_u32 v14, v14, v15
    v_add_u32 v58, s3, v14
    v_xor_b32 v57, 64, v58
    s_lshl_b32 s100, s4, 6
    s_and_b32 s4, s58, 2
    s_lshl_b32 s4, s4, 4
    v_and_b32 v14, 31, v1
    v_add_u32 v14, s4, v14
    s_lshl_b32 s3, s60, 5
    s_add_u32 s3, s3, s100
    v_lshrrev_b32 v15, 5, v1
    v_lshl_add_u32 v15, v15, 3, s3
    v_bfe_u32 v59, v1, 1, 1
    v_lshlrev_b32 v59, 6, v59
    v_xor_b32 v59, v59, v15
    v_lshl_add_u32 v59, v14, 7, v59
    v_add_u32 v59, 122880, v59
    s_lshl_b32 s3, s56, 7
    s_lshl_b32 s4, s97, 6
    s_add_u32 s3, s3, s4
    v_add_u32 v14, s3, v14
    v_mul_u32_u24 v14, 896, v14
    s_lshl_b32 s3, s23, 7
    v_add3_u32 v85, v14, v15, s3
    s_mul_i32 s3, s57, 7
    s_lshr_b32 s3, s3, 1
    v_lshrrev_b32 v14, 5, v1
    v_and_b32 v69, 31, v1
    v_add3_u32 v15, v14, s3, 0
    v_lshrrev_b32 v65, 2, v15
    v_lshlrev_b32 v65, 17, v65
    v_and_b32 v15, 3, v15
    v_lshl_add_u32 v65, v15, 9, v65
    v_add3_u32 v15, v14, s3, 2
    v_lshrrev_b32 v66, 2, v15
    v_lshlrev_b32 v66, 17, v66
    v_and_b32 v15, 3, v15
    v_lshl_add_u32 v66, v15, 9, v66
    s_and_b32 s82, s58, 1
    s_cmp_eq_u32 s82, 1
    s_cselect_b64 s[18:19], -1, 0
    v_cndmask_b32 v68, v65, v66, s[18:19]
    v_lshl_add_u32 v67, v69, 4, v68
    s_lshl_b32 s4, s82, 1
    v_add_u32 v15, s4, v14
    v_lshlrev_b32 v15, 2, v15
    v_sub_u32 v15, v69, v15
    v_and_b32 v15, 31, v15
    v_lshl_add_u32 v68, v15, 4, v68
    v_lshl_add_u32 v65, v69, 4, v65
    v_lshl_add_u32 v66, v69, 4, v66
    s_lshl_b32 s4, s56, 2
    s_add_u32 s5, s4, s59
    s_lshl_b32 s72, s5, 11
    s_lshl_b32 s6, s57, 17
    s_add_u32 s73, s72, s6
    s_add_u32 s73, s73, 6291456
    s_lshr_b32 s6, s58, 1
    s_mul_i32 s6, s6, 3
    s_add_u32 s4, s4, s6
    s_add_u32 s4, s4, 888
    s_lshl_b32 s74, s4, 11
    s_lshl_b32 s6, s6, 11
    s_lshl_b32 s75, s82, 10
    s_add_u32 s75, s75, s6
    s_lshl_b32 s3, s60, 2
    s_sub_u32 s76, s59, s3
    s_add_u32 s76, s76, 4
    s_lshl_b32 s3, s76, 11
    s_add_u32 s3, s3, 90112
    v_lshl_add_u32 v2, v1, 4, s3
    v_bfe_u32 v14, v1, 4, 1
    v_and_b32 v3, 3, v1
    v_lshl_add_u32 v14, v14, 2, v3
    v_lshrrev_b32 v15, 1, v14
    v_lshrrev_b32 v3, 5, v1
    v_add_u32 v3, v3, v15
    v_bfe_u32 v4, v1, 2, 2
    v_lshl_add_u32 v8, v3, 2, v4
    v_lshl_add_u32 v15, v15, 9, s3
    v_and_b32 v3, 1, v1
    v_lshl_add_u32 v15, v3, 3, v15
    v_add_u32 v15, 24576, v15
    s_and_b32 s4, s57, 1
    s_mul_i32 s4, s4, 7
    s_sub_u32 s4, 7, s4
    v_cmp_eq_u32 s[18:19], s4, v14
    v_mov_b32 v14, 140288
    v_add_u32 v3, 0, v8
    v_and_b32 v3, 31, v3
    v_lshl_add_u32 v3, v3, 4, v15
    v_cndmask_b32 v3, v3, v14, s[18:19]
    v_add_u32 v4, 8, v8
    v_and_b32 v4, 31, v4
    v_lshl_add_u32 v4, v4, 4, v15
    v_cndmask_b32 v4, v4, v14, s[18:19]
    v_add_u32 v5, 16, v8
    v_and_b32 v5, 31, v5
    v_lshl_add_u32 v5, v5, 4, v15
    v_cndmask_b32 v5, v5, v14, s[18:19]
    v_add_u32 v6, 24, v8
    v_and_b32 v6, 31, v6
    v_lshl_add_u32 v6, v6, 4, v15
    v_cndmask_b32 v6, v6, v14, s[18:19]
    s_lshl_b32 s3, s56, 2
    s_sub_i32 s77, 8, s3
    s_sub_i32 s77, s77, s76
    s_mov_b32 s3, 0
    s_lshl_b32 s5, s57, 8
    v_lshrrev_b32 v14, 3, v1
    v_bfe_u32 v15, v1, 4, 1
    v_lshlrev_b32 v15, 2, v15
    v_xor_b32 v15, v15, v1
    v_and_b32 v15, 7, v15
    v_add_u32 v14, s3, v14
    v_mul_u32_u24 v14, 3584, v14
    v_lshl_add_u32 v14, v15, 4, v14
    v_add_u32 v9, s5, v14
    s_mul_i32 s78, s58, 28672
    s_lshl_b32 s79, s58, 10
    s_mul_i32 s80, s59, 28672
    s_lshl_b32 s81, s59, 10
    s_mul_i32 s3, s59, 4608
    s_add_u32 s3, s3, 139264
    v_lshl_add_u32 v7, v1, 4, s3
    s_lshl_b32 s4, s60, 8
    s_add_u32 s3, s3, s4
    s_add_u32 s3, s3, 4096
    v_lshl_add_u32 v8, v1, 2, s3
    v_xor_b32 v11, 256, v8
    v_lshl_add_u32 v10, v1, 4, s73
    v_lshrrev_b32 v14, 4, v1
    v_sub_u32 v14, s56, v14
    v_max_i32 v14, 0, v14
    v_and_b32 v15, 15, v1
    v_cmp_le_u32 vcc, 7, v15
    s_nop 1
    v_cndmask_b32 v62, 0, 1, vcc
    v_and_b32 v60, 12, v14
    v_lshl_add_u32 v60, v62, 1, v60
    v_bfe_u32 v61, v14, 1, 1
    v_add_u32 v60, v60, v61
    v_and_b32 v61, 1, v14
    v_sub_u32 v61, v61, v62
    v_mad_i32_i24 v61, v61, 7, v15
    v_cmp_le_u32 vcc, 14, v15
    s_nop 1
    v_cndmask_b32 v60, v60, v14, vcc
    v_cndmask_b32 v61, v61, v15, vcc
    v_mov_b32 v62, s56
    v_cmp_le_u32 vcc, 48, v1
    s_nop 1
    v_cndmask_b32 v60, v60, v62, vcc
    v_cndmask_b32 v61, v61, v15, vcc
    v_lshl_add_u32 v60, v60, 4, v61
    v_lshlrev_b32 v14, 7, v60
    v_add_u32 v61, 33685504, v14
P1J_4:
    s_mov_b32 s16, s72
    s_mov_b32 s101, s73
    s_mov_b32 s14, s74
    s_mov_b32 s15, s75
    s_mov_b32 s7, s76
    s_mov_b32 s8, s77
    s_mov_b32 s10, s78
    s_mov_b32 s11, s79
    v_mov_b32 v14, 140288
    v_lshl_add_u32 v14, v1, 11, v14
    v_mov_b32 v70, 0x3f80
    v_mov_b32 v71, 0
    s_mov_b64 exec, 31
    ds_write_b64 v14, v[70:71]
    s_mov_b64 exec, -1
    s_lshl_b32 s4, s56, 11
    s_lshl_b32 s5, s57, 7
    s_add_u32 s4, s4, s5
    s_add_u32 s4, s4, 33685504
    s_lshl_b32 s5, s61, 28
    s_or_b32 s5, s5, s1
    v_mov_b32 v13, s4
    v_mov_b32 v14, s0
    v_mov_b32 v15, s5
    s_waitcnt vmcnt(0) lgkmcnt(0)
    s_barrier
    s_cmp_lg_u32 s58, 0
    s_cbranch_scc1 PUB_13
    s_mov_b64 exec, 1
    buffer_store_dwordx2 v[14:15], v13, s[52:55], 0 offen sc1
    s_mov_b64 exec, -1
PUB_13:
    ds_read_b64_tr_b16 v[88:89], v58 offset:0
    ds_read_b64_tr_b16 v[90:91], v58 offset:512
    ds_read_b64_tr_b16 v[92:93], v57 offset:0
    ds_read_b64_tr_b16 v[94:95], v57 offset:512
    ds_read_b64_tr_b16 v[96:97], v58 offset:2048
    ds_read_b64_tr_b16 v[98:99], v58 offset:2560
    ds_read_b64_tr_b16 v[100:101], v57 offset:2048
    ds_read_b64_tr_b16 v[102:103], v57 offset:2560
    ds_read_b64_tr_b16 v[104:105], v58 offset:3072
    ds_read_b64_tr_b16 v[106:107], v58 offset:3584
    ds_read_b64_tr_b16 v[108:109], v57 offset:3072
    ds_read_b64_tr_b16 v[110:111], v57 offset:3584
    ds_read_b64_tr_b16 v[112:113], v58 offset:5120
    ds_read_b64_tr_b16 v[114:115], v58 offset:5632
    ds_read_b64_tr_b16 v[116:117], v57 offset:5120
    ds_read_b64_tr_b16 v[118:119], v57 offset:5632
    ds_read_b64_tr_b16 v[120:121], v58 offset:7168
    ds_read_b64_tr_b16 v[122:123], v58 offset:7680
    ds_read_b64_tr_b16 v[124:125], v57 offset:7168
    ds_read_b64_tr_b16 v[126:127], v57 offset:7680
    ds_read_b64_tr_b16 v[128:129], v58 offset:9216
    ds_read_b64_tr_b16 v[130:131], v58 offset:9728
    ds_read_b64_tr_b16 v[132:133], v57 offset:9216
    ds_read_b64_tr_b16 v[134:135], v57 offset:9728
    ds_read_b64_tr_b16 v[136:137], v58 offset:10240
    ds_read_b64_tr_b16 v[138:139], v58 offset:10752
    ds_read_b64_tr_b16 v[140:141], v57 offset:10240
    ds_read_b64_tr_b16 v[142:143], v57 offset:10752
    ds_read_b64_tr_b16 v[232:233], v58 offset:12288
    ds_read_b64_tr_b16 v[234:235], v58 offset:12800
    ds_read_b64_tr_b16 v[236:237], v57 offset:12288
    ds_read_b64_tr_b16 v[238:239], v57 offset:12800
    ds_read_b64 v[80:81], v59
    ds_read_b64 v[82:83], v59 offset:16
L_P2POLL:
    s_cmp_lg_u32 s58, 0
    s_cbranch_scc1 P2W_14
    s_mov_b32 exec_lo, 0xffffffff
    s_mov_b32 exec_hi, 0xffffffff
    s_mov_b32 s22, 200000
    s_nop 15
POLLKV_16:
    buffer_load_dwordx2 v[62:63], v61, s[52:55], 0 offen sc1
    s_waitcnt vmcnt(0)
    v_xor_b32 v64, s1, v63
    v_and_b32 v64, 0xfffffff, v64
    v_xor_b32 v62, s0, v62
    v_or_b32 v64, v64, v62
    v_cmp_ne_u32 vcc, 0, v64
    s_sub_u32 s22, s22, 1
    s_cbranch_scc1 PDONEKV_17
    s_nop 2
    s_cbranch_vccz PDONEKV_17
    s_mov_b64 exec, vcc
    s_sleep 1
    s_branch POLLKV_16
PDONEKV_17:
    s_mov_b64 exec, -1
    s_mov_b32 exec_lo, 0x0
    s_mov_b32 exec_hi, 0xffff0000
    v_lshrrev_b32 v63, 28, v63
    v_cmp_ne_u32 vcc, s61, v63
    s_mov_b64 exec, -1
    s_nop 0
    s_cmp_eq_u64 vcc, 0
    s_cselect_b32 s3, 1, 0
    v_mov_b32 v15, s3
    v_mov_b32 v14, 163328
    ds_write_b32 v14, v15
P2W_14:
    s_waitcnt lgkmcnt(0)
    s_barrier
    s_add_u32 s6, s14, 0
    s_add_u32 m0, s15, 90112
    s_nop 0
    buffer_load_dwordx4 v67, s[52:55], s6 offen sc1 lds
    s_add_u32 s6, s14, 2048
    s_add_u32 m0, s15, 92160
    s_nop 0
    buffer_load_dwordx4 v67, s[52:55], s6 offen sc1 lds
    s_add_u32 s6, s14, 4096
    s_add_u32 m0, s15, 94208
    s_nop 0
    buffer_load_dwordx4 v67, s[52:55], s6 offen sc1 lds
    buffer_load_dwordx4 v[72:75], v65, s[52:55], s16 offen sc1
    buffer_load_dwordx4 v[76:79], v66, s[52:55], s16 offen sc1
    v_mov_b32 v14, 163328
    ds_read_b32 v13, v14
    v_mov_b32 v14, s96
    v_cndmask_b32 v224, v14, 0, s[20:21]
    v_mov_b32 v225, 0
    v_mov_b32 v226, 0
    v_mov_b32 v227, 0
    v_mov_b32 v229, 0
    v_mov_b32 v230, 0
    v_mov_b32 v231, 0
    v_mov_b32 v16, 0
    v_mov_b32 v17, 0
    v_mov_b32 v18, 0
    v_mov_b32 v19, 0
    v_mov_b32 v20, 0
    v_mov_b32 v21, 0
    v_mov_b32 v22, 0
    v_mov_b32 v23, 0
    v_mov_b32 v24, 0
    v_mov_b32 v25, 0
    v_mov_b32 v26, 0
    v_mov_b32 v27, 0
    v_mov_b32 v28, 0
    v_mov_b32 v29, 0
    v_mov_b32 v30, 0
    v_mov_b32 v31, 0
    v_and_b32 v14, 31, v1
    v_lshrrev_b32 v15, 5, v1
    v_lshlrev_b32 v15, 2, v15
    v_sub_u32 v14, v14, v15
    v_cmp_le_i32 s[64:65], 0, v14
    v_cmp_le_i32 s[66:67], 1, v14
    v_cmp_le_i32 s[68:69], 2, v14
    v_cmp_le_i32 s[70:71], 3, v14
    v_cmp_le_i32 s[72:73], 8, v14
    v_cmp_le_i32 s[74:75], 9, v14
    v_cmp_le_i32 s[76:77], 10, v14
    v_cmp_le_i32 s[78:79], 11, v14
    v_cmp_le_i32 s[80:81], 16, v14
    v_cmp_le_i32 s[82:83], 17, v14
    v_cmp_le_i32 s[84:85], 18, v14
    v_cmp_le_i32 s[86:87], 19, v14
    v_cmp_le_i32 s[88:89], 24, v14
    v_cmp_le_i32 s[90:91], 25, v14
    v_cmp_le_i32 s[92:93], 26, v14
    v_cmp_le_i32 s[94:95], 27, v14
    s_waitcnt lgkmcnt(0)
    v_readfirstlane_b32 s62, v13
    s_waitcnt vmcnt(0)
    s_barrier
    s_add_u32 s6, s14, 1835008
    s_add_u32 m0, s15, 114688
    s_nop 0
    buffer_load_dwordx4 v68, s[52:55], s6 offen sc1 lds
    s_add_u32 s6, s14, 1837056
    s_add_u32 m0, s15, 116736
    s_nop 0
    buffer_load_dwordx4 v68, s[52:55], s6 offen sc1 lds
    s_add_u32 s6, s14, 1839104
    s_add_u32 m0, s15, 118784
    s_nop 0
    buffer_load_dwordx4 v68, s[52:55], s6 offen sc1 lds
    ds_read_b128 v[32:35], v2 offset:0
    ds_read_b128 v[36:39], v2 offset:1024
    ds_read_b128 v[40:43], v2 offset:2048
    ds_read_b128 v[44:47], v2 offset:3072
    ds_read_b128 v[48:51], v2 offset:4096
    ds_read_b128 v[52:55], v2 offset:5120
    ds_read_b128 v[56:59], v2 offset:6144
    ds_read_b128 v[60:63], v2 offset:7168
    ds_read_b128 v[64:67], v2 offset:8192
    ds_read_b128 v[68:71], v2 offset:9216
    s_bitcmp1_b32 s57, 0
    s_cbranch_scc1 ZF_18
    v_cndmask_b32 v78, v78, 0, s[20:21]
    v_cndmask_b32 v79, v79, 0, s[20:21]
    s_branch ZF_19
ZF_18:
    v_cndmask_b32 v72, 0, v72, s[20:21]
    v_cndmask_b32 v73, 0, v73, s[20:21]
ZF_19:
    v_mov_b32 v12, 0xf149f2ca
    v_mov_b32 v13, 0xf149f2ca
    s_waitcnt lgkmcnt(8)
    s_cmp_gt_i32 s8, 0
    s_cbranch_scc1 QS_20
    v_mfma_f32_32x32x16_bf16 v[144:159], v[32:35], v[72:75], 0
    v_mfma_f32_32x32x16_bf16 v[144:159], v[36:39], v[76:79], v[144:159]
QS_20:
    s_waitcnt lgkmcnt(6)
    s_cmp_gt_i32 s8, 1
    s_cbranch_scc1 QS_21
    v_mfma_f32_32x32x16_bf16 v[160:175], v[40:43], v[72:75], 0
    v_mfma_f32_32x32x16_bf16 v[160:175], v[44:47], v[76:79], v[160:175]
QS_21:
    s_waitcnt lgkmcnt(4)
    s_cmp_gt_i32 s8, 2
    s_cbranch_scc1 QS_22
    v_mfma_f32_32x32x16_bf16 v[176:191], v[48:51], v[72:75], 0
    v_mfma_f32_32x32x16_bf16 v[176:191], v[52:55], v[76:79], v[176:191]
QS_22:
    s_waitcnt lgkmcnt(2)
    s_cmp_gt_i32 s8, 3
    s_cbranch_scc1 QS_23
    v_mfma_f32_32x32x16_bf16 v[192:207], v[56:59], v[72:75], 0
    v_mfma_f32_32x32x16_bf16 v[192:207], v[60:63], v[76:79], v[192:207]
QS_23:
    s_waitcnt lgkmcnt(0)
    s_cmp_eq_u32 s60, 1
    s_cbranch_scc1 QS_24
    v_mfma_f32_32x32x16_bf16 v[208:223], v[64:67], v[72:75], 0
    v_mfma_f32_32x32x16_bf16 v[208:223], v[68:71], v[76:79], v[208:223]
QS_24:
    v_mov_b32 v14, 0xf149f2ca
    s_cmp_gt_i32 s8, 0
    s_cbranch_scc1 MX_25
    s_cmp_eq_u32 s60, 0
    s_cbranch_scc1 MK_26
    v_cndmask_b32 v144, v144, v14, s[64:65]
    v_cndmask_b32 v145, v145, v14, s[66:67]
    v_cndmask_b32 v146, v146, v14, s[68:69]
    v_cndmask_b32 v147, v147, v14, s[70:71]
    v_cndmask_b32 v148, v148, v14, s[72:73]
    v_cndmask_b32 v149, v149, v14, s[74:75]
    v_cndmask_b32 v150, v150, v14, s[76:77]
    v_cndmask_b32 v151, v151, v14, s[78:79]
    v_cndmask_b32 v152, v152, v14, s[80:81]
    v_cndmask_b32 v153, v153, v14, s[82:83]
    v_cndmask_b32 v154, v154, v14, s[84:85]
    v_cndmask_b32 v155, v155, v14, s[86:87]
    v_cndmask_b32 v156, v156, v14, s[88:89]
    v_cndmask_b32 v157, v157, v14, s[90:91]
    v_cndmask_b32 v158, v158, v14, s[92:93]
    v_cndmask_b32 v159, v159, v14, s[94:95]
MK_26:
    v_max3_f32 v12, v12, v144, v145
    v_max3_f32 v13, v13, v146, v147
    v_max3_f32 v12, v12, v148, v149
    v_max3_f32 v13, v13, v150, v151
    v_max3_f32 v12, v12, v152, v153
    v_max3_f32 v13, v13, v154, v155
    v_max3_f32 v12, v12, v156, v157
    v_max3_f32 v13, v13, v158, v159
MX_25:
    s_cmp_eq_u32 s17, 0
    s_cbranch_scc1 NB_27
    s_add_u32 s3, s10, 0
    s_add_u32 m0, s11, 0
    s_nop 0
    buffer_load_dwordx4 v9, s[36:39], s3 offen lds
NB_27:
    s_cmp_gt_i32 s8, 1
    s_cbranch_scc1 MX_28
    v_max3_f32 v12, v12, v160, v161
    v_max3_f32 v13, v13, v162, v163
    v_max3_f32 v12, v12, v164, v165
    v_max3_f32 v13, v13, v166, v167
    v_max3_f32 v12, v12, v168, v169
    v_max3_f32 v13, v13, v170, v171
    v_max3_f32 v12, v12, v172, v173
    v_max3_f32 v13, v13, v174, v175
MX_28:
    s_cmp_eq_u32 s17, 0
    s_cbranch_scc1 NB_29
    s_add_u32 s3, s10, 229376
    s_add_u32 m0, s11, 8192
    s_nop 0
    buffer_load_dwordx4 v9, s[36:39], s3 offen lds
NB_29:
    s_cmp_gt_i32 s8, 2
    s_cbranch_scc1 MX_30
    v_max3_f32 v12, v12, v176, v177
    v_max3_f32 v13, v13, v178, v179
    v_max3_f32 v12, v12, v180, v181
    v_max3_f32 v13, v13, v182, v183
    v_max3_f32 v12, v12, v184, v185
    v_max3_f32 v13, v13, v186, v187
    v_max3_f32 v12, v12, v188, v189
    v_max3_f32 v13, v13, v190, v191
MX_30:
    s_cmp_eq_u32 s17, 0
    s_cbranch_scc1 NB_31
    s_add_u32 s3, s10, 458752
    s_add_u32 m0, s11, 16384
    s_nop 0
    buffer_load_dwordx4 v9, s[36:39], s3 offen lds
NB_31:
    s_cmp_gt_i32 s8, 3
    s_cbranch_scc1 MX_32
    v_max3_f32 v12, v12, v192, v193
    v_max3_f32 v13, v13, v194, v195
    v_max3_f32 v12, v12, v196, v197
    v_max3_f32 v13, v13, v198, v199
    v_max3_f32 v12, v12, v200, v201
    v_max3_f32 v13, v13, v202, v203
    v_max3_f32 v12, v12, v204, v205
    v_max3_f32 v13, v13, v206, v207
MX_32:
    s_cmp_eq_u32 s17, 0
    s_cbranch_scc1 NB_33
    s_add_u32 s3, s10, 688128
    s_add_u32 m0, s11, 24576
    s_nop 0
    buffer_load_dwordx4 v9, s[36:39], s3 offen lds
NB_33:
    s_cmp_eq_u32 s60, 1
    s_cbranch_scc1 MX_34
    v_cndmask_b32 v208, v14, v208, s[64:65]
    v_cndmask_b32 v209, v14, v209, s[66:67]
    v_cndmask_b32 v210, v14, v210, s[68:69]
    v_cndmask_b32 v211, v14, v211, s[70:71]
    v_cndmask_b32 v212, v14, v212, s[72:73]
    v_cndmask_b32 v213, v14, v213, s[74:75]
    v_cndmask_b32 v214, v14, v214, s[76:77]
    v_cndmask_b32 v215, v14, v215, s[78:79]
    v_cndmask_b32 v216, v14, v216, s[80:81]
    v_cndmask_b32 v217, v14, v217, s[82:83]
    v_cndmask_b32 v218, v14, v218, s[84:85]
    v_cndmask_b32 v219, v14, v219, s[86:87]
    v_cndmask_b32 v220, v14, v220, s[88:89]
    v_cndmask_b32 v221, v14, v221, s[90:91]
    v_cndmask_b32 v222, v14, v222, s[92:93]
    v_cndmask_b32 v223, v14, v223, s[94:95]
    v_max3_f32 v12, v12, v208, v209
    v_max3_f32 v13, v13, v210, v211
    v_max3_f32 v12, v12, v212, v213
    v_max3_f32 v13, v13, v214, v215
    v_max3_f32 v12, v12, v216, v217
    v_max3_f32 v13, v13, v218, v219
    v_max3_f32 v12, v12, v220, v221
    v_max3_f32 v13, v13, v222, v223
MX_34:
    s_cmp_eq_u32 s17, 0
    s_cbranch_scc1 NB_35
    s_add_u32 s3, s10, 917504
    s_add_u32 m0, s11, 32768
    s_nop 0
    buffer_load_dwordx4 v9, s[36:39], s3 offen lds
NB_35:
    v_max_f32 v12, v12, v13
    v_mov_b32 v14, v12
    s_nop 1
    v_permlane32_swap_b32 v14, v12
    v_max_f32 v12, v12, v14
    ds_write_b32 v8, v12
    s_cmp_eq_u32 s17, 1
    s_cbranch_scc1 VW_36
    s_waitcnt vmcnt(0)
VW_36:
    s_waitcnt vmcnt(5) lgkmcnt(0)
    s_barrier
    ds_read_b32 v14, v11
    ds_read_b64_tr_b16 v[32:33], v3 offset:0
    ds_read_b64_tr_b16 v[34:35], v4 offset:0
    ds_read_b64_tr_b16 v[36:37], v5 offset:0
    ds_read_b64_tr_b16 v[38:39], v6 offset:0
    ds_read_b64_tr_b16 v[40:41], v3 offset:2048
    ds_read_b64_tr_b16 v[42:43], v4 offset:2048
    ds_read_b64_tr_b16 v[44:45], v5 offset:2048
    ds_read_b64_tr_b16 v[46:47], v6 offset:2048
    ds_read_b64_tr_b16 v[48:49], v3 offset:4096
    ds_read_b64_tr_b16 v[50:51], v4 offset:4096
    ds_read_b64_tr_b16 v[52:53], v5 offset:4096
    ds_read_b64_tr_b16 v[54:55], v6 offset:4096
    ds_read_b64_tr_b16 v[56:57], v3 offset:6144
    ds_read_b64_tr_b16 v[58:59], v4 offset:6144
    ds_read_b64_tr_b16 v[60:61], v5 offset:6144
    ds_read_b64_tr_b16 v[62:63], v6 offset:6144
    ds_read_b64_tr_b16 v[64:65], v3 offset:8192
    ds_read_b64_tr_b16 v[66:67], v4 offset:8192
    ds_read_b64_tr_b16 v[68:69], v5 offset:8192
    ds_read_b64_tr_b16 v[70:71], v6 offset:8192
    s_waitcnt lgkmcnt(15)
    v_max_f32 v12, v12, v14
    v_cvt_pk_bf16_f32 v14, -v12, 0
    v_lshlrev_b32 v14, 16, v14
    v_sub_f32 v14, -v12, v14
    v_cvt_pk_bf16_f32 v228, -v12, v14
    s_cmp_gt_i32 s8, 0
    s_cbranch_scc1 SB_38
    v_mfma_f32_32x32x16_bf16 v[144:159], v[224:227], v[228:231], v[144:159]
SB_38:
    s_cmp_gt_i32 s8, 1
    s_cbranch_scc1 SB_39
    v_mfma_f32_32x32x16_bf16 v[160:175], v[224:227], v[228:231], v[160:175]
SB_39:
    s_cmp_gt_i32 s8, 2
    s_cbranch_scc1 SB_40
    v_mfma_f32_32x32x16_bf16 v[176:191], v[224:227], v[228:231], v[176:191]
SB_40:
    s_cmp_gt_i32 s8, 3
    s_cbranch_scc1 SB_41
    v_mfma_f32_32x32x16_bf16 v[192:207], v[224:227], v[228:231], v[192:207]
SB_41:
    s_cmp_eq_u32 s60, 1
    s_cbranch_scc1 SB_42
    v_mfma_f32_32x32x16_bf16 v[208:223], v[224:227], v[228:231], v[208:223]
SB_42:
    s_cmp_eq_u32 s17, 0
    s_cbranch_scc1 NB_43
    s_add_u32 s3, s10, 1146880
    s_add_u32 m0, s11, 40960
    s_nop 0
    buffer_load_dwordx4 v9, s[36:39], s3 offen lds
    s_add_u32 s3, s10, 1376256
    s_add_u32 m0, s11, 49152
    s_nop 0
    buffer_load_dwordx4 v9, s[36:39], s3 offen lds
    s_add_u32 s3, s10, 128
    s_add_u32 m0, s11, 57344
    s_nop 0
    buffer_load_dwordx4 v9, s[36:39], s3 offen lds
    s_add_u32 s3, s10, 229504
    s_add_u32 m0, s11, 65536
    s_nop 0
    buffer_load_dwordx4 v9, s[36:39], s3 offen lds
NB_43:
    s_waitcnt lgkmcnt(0)
    s_cmp_gt_i32 s8, 0
    s_cbranch_scc1 PS_44
    v_exp_f32 v144, v144
    v_exp_f32 v145, v145
    v_exp_f32 v146, v146
    v_exp_f32 v147, v147
    v_exp_f32 v148, v148
    v_exp_f32 v149, v149
    v_exp_f32 v150, v150
    v_exp_f32 v151, v151
    v_cvt_pk_bf16_f32 v144, v144, v145
    v_cvt_pk_bf16_f32 v145, v146, v147
    v_cvt_pk_bf16_f32 v146, v148, v149
    v_cvt_pk_bf16_f32 v147, v150, v151
    v_exp_f32 v152, v152
    v_exp_f32 v153, v153
    v_exp_f32 v154, v154
    v_exp_f32 v155, v155
    v_exp_f32 v156, v156
    v_exp_f32 v157, v157
    v_exp_f32 v158, v158
    v_exp_f32 v159, v159
    v_cvt_pk_bf16_f32 v152, v152, v153
    v_cvt_pk_bf16_f32 v153, v154, v155
    v_cvt_pk_bf16_f32 v154, v156, v157
    v_cvt_pk_bf16_f32 v155, v158, v159
    v_mfma_f32_32x32x16_bf16 v[16:31], v[32:35], v[144:147], v[16:31]
    s_nop 0
    v_mfma_f32_32x32x16_bf16 v[16:31], v[36:39], v[152:155], v[16:31]
PS_44:
    s_cmp_eq_u32 s17, 0
    s_cbranch_scc1 NB_45
    s_add_u32 s3, s10, 458880
    s_add_u32 m0, s11, 73728
    s_nop 0
    buffer_load_dwordx4 v9, s[36:39], s3 offen lds
    s_add_u32 s3, s10, 688256
    s_add_u32 m0, s11, 81920
    s_nop 0
    buffer_load_dwordx4 v9, s[36:39], s3 offen lds
    s_add_u32 s3, s10, 917632
    s_add_u32 m0, s11, 90112
    s_nop 0
    buffer_load_dwordx4 v9, s[36:39], s3 offen lds
NB_45:
    s_cmp_gt_i32 s8, 1
    s_cbranch_scc1 PS_46
    v_exp_f32 v160, v160
    v_exp_f32 v161, v161
    v_exp_f32 v162, v162
    v_exp_f32 v163, v163
    v_exp_f32 v164, v164
    v_exp_f32 v165, v165
    v_exp_f32 v166, v166
    v_exp_f32 v167, v167
    v_cvt_pk_bf16_f32 v160, v160, v161
    v_cvt_pk_bf16_f32 v161, v162, v163
    v_cvt_pk_bf16_f32 v162, v164, v165
    v_cvt_pk_bf16_f32 v163, v166, v167
    v_exp_f32 v168, v168
    v_exp_f32 v169, v169
    v_exp_f32 v170, v170
    v_exp_f32 v171, v171
    v_exp_f32 v172, v172
    v_exp_f32 v173, v173
    v_exp_f32 v174, v174
    v_exp_f32 v175, v175
    v_cvt_pk_bf16_f32 v168, v168, v169
    v_cvt_pk_bf16_f32 v169, v170, v171
    v_cvt_pk_bf16_f32 v170, v172, v173
    v_cvt_pk_bf16_f32 v171, v174, v175
    v_mfma_f32_32x32x16_bf16 v[16:31], v[40:43], v[160:163], v[16:31]
    s_nop 0
    v_mfma_f32_32x32x16_bf16 v[16:31], v[44:47], v[168:171], v[16:31]
PS_46:
    s_cmp_eq_u32 s17, 0
    s_cbranch_scc1 NB_47
    s_add_u32 s3, s10, 1147008
    s_add_u32 m0, s11, 98304
    s_nop 0
    buffer_load_dwordx4 v9, s[36:39], s3 offen lds
    s_add_u32 s3, s10, 1376384
    s_add_u32 m0, s11, 106496
    s_nop 0
    buffer_load_dwordx4 v9, s[36:39], s3 offen lds
NB_47:
    s_cmp_gt_i32 s8, 2
    s_cbranch_scc1 PS_48
    v_exp_f32 v176, v176
    v_exp_f32 v177, v177
    v_exp_f32 v178, v178
    v_exp_f32 v179, v179
    v_exp_f32 v180, v180
    v_exp_f32 v181, v181
    v_exp_f32 v182, v182
    v_exp_f32 v183, v183
    v_cvt_pk_bf16_f32 v176, v176, v177
    v_cvt_pk_bf16_f32 v177, v178, v179
    v_cvt_pk_bf16_f32 v178, v180, v181
    v_cvt_pk_bf16_f32 v179, v182, v183
    v_exp_f32 v184, v184
    v_exp_f32 v185, v185
    v_exp_f32 v186, v186
    v_exp_f32 v187, v187
    v_exp_f32 v188, v188
    v_exp_f32 v189, v189
    v_exp_f32 v190, v190
    v_exp_f32 v191, v191
    v_cvt_pk_bf16_f32 v184, v184, v185
    v_cvt_pk_bf16_f32 v185, v186, v187
    v_cvt_pk_bf16_f32 v186, v188, v189
    v_cvt_pk_bf16_f32 v187, v190, v191
    v_mfma_f32_32x32x16_bf16 v[16:31], v[48:51], v[176:179], v[16:31]
    s_nop 0
    v_mfma_f32_32x32x16_bf16 v[16:31], v[52:55], v[184:187], v[16:31]
PS_48:
    s_cmp_gt_i32 s8, 3
    s_cbranch_scc1 PS_49
    v_exp_f32 v192, v192
    v_exp_f32 v193, v193
    v_exp_f32 v194, v194
    v_exp_f32 v195, v195
    v_exp_f32 v196, v196
    v_exp_f32 v197, v197
    v_exp_f32 v198, v198
    v_exp_f32 v199, v199
    v_cvt_pk_bf16_f32 v192, v192, v193
    v_cvt_pk_bf16_f32 v193, v194, v195
    v_cvt_pk_bf16_f32 v194, v196, v197
    v_cvt_pk_bf16_f32 v195, v198, v199
    v_exp_f32 v200, v200
    v_exp_f32 v201, v201
    v_exp_f32 v202, v202
    v_exp_f32 v203, v203
    v_exp_f32 v204, v204
    v_exp_f32 v205, v205
    v_exp_f32 v206, v206
    v_exp_f32 v207, v207
    v_cvt_pk_bf16_f32 v200, v200, v201
    v_cvt_pk_bf16_f32 v201, v202, v203
    v_cvt_pk_bf16_f32 v202, v204, v205
    v_cvt_pk_bf16_f32 v203, v206, v207
    v_mfma_f32_32x32x16_bf16 v[16:31], v[56:59], v[192:195], v[16:31]
    s_nop 0
    v_mfma_f32_32x32x16_bf16 v[16:31], v[60:63], v[200:203], v[16:31]
PS_49:
    s_cmp_eq_u32 s60, 1
    s_cbranch_scc1 PS_50
    v_exp_f32 v208, v208
    v_exp_f32 v209, v209
    v_exp_f32 v210, v210
    v_exp_f32 v211, v211
    v_exp_f32 v212, v212
    v_exp_f32 v213, v213
    v_exp_f32 v214, v214
    v_exp_f32 v215, v215
    v_cvt_pk_bf16_f32 v208, v208, v209
    v_cvt_pk_bf16_f32 v209, v210, v211
    v_cvt_pk_bf16_f32 v210, v212, v213
    v_cvt_pk_bf16_f32 v211, v214, v215
    v_exp_f32 v216, v216
    v_exp_f32 v217, v217
    v_exp_f32 v218, v218
    v_exp_f32 v219, v219
    v_exp_f32 v220, v220
    v_exp_f32 v221, v221
    v_exp_f32 v222, v222
    v_exp_f32 v223, v223
    v_cvt_pk_bf16_f32 v216, v216, v217
    v_cvt_pk_bf16_f32 v217, v218, v219
    v_cvt_pk_bf16_f32 v218, v220, v221
    v_cvt_pk_bf16_f32 v219, v222, v223
    v_mfma_f32_32x32x16_bf16 v[16:31], v[64:67], v[208:211], v[16:31]
    s_nop 0
    v_mfma_f32_32x32x16_bf16 v[16:31], v[68:71], v[216:219], v[16:31]
PS_50:
    s_cmp_eq_u32 s60, 1
    s_cbranch_scc0 MG_51
    s_nop 9
    ds_write_b128 v7, v[16:19] offset:0
    ds_write_b128 v7, v[20:23] offset:1024
    ds_write_b128 v7, v[24:27] offset:2048
    ds_write_b128 v7, v[28:31] offset:3072
MG_51:
    s_lshl_b32 s4, s56, 9
    s_lshl_b32 s5, s59, 7
    s_add_u32 s4, s4, s5
    s_lshl_b32 s5, s57, 3
    s_add_u32 s4, s4, s5
    s_add_u32 s4, s4, 33570816
    s_lshl_b32 s5, s61, 28
    s_or_b32 s5, s5, s1
    v_mov_b32 v13, s4
    v_mov_b32 v60, s0
    v_mov_b32 v61, s5
    s_waitcnt vmcnt(0) lgkmcnt(0)
    s_barrier
    s_cmp_eq_u32 s60, 0
    s_cbranch_scc0 MG_52
    ds_read_b128 v[44:47], v7 offset:3072
    ds_read_b128 v[32:35], v7 offset:0
    ds_read_b128 v[36:39], v7 offset:1024
    ds_read_b128 v[40:43], v7 offset:2048
    s_bitcmp1_b32 s57, 0
    s_cselect_b64 s[18:19], -1, 0
    s_waitcnt lgkmcnt(2)
    v_pk_add_f32 v[28:29], v[28:29], v[44:45]
    v_pk_add_f32 v[30:31], v[30:31], v[46:47]
    v_pk_add_f32 v[16:17], v[16:17], v[32:33]
    v_pk_add_f32 v[18:19], v[18:19], v[34:35]
    v_cndmask_b32 v14, v16, v28, s[20:21]
    v_mov_b32 v15, v14
    s_nop 1
    v_permlane32_swap_b32 v14, v15
    v_cndmask_b32 v15, v15, v14, s[18:19]
    v_rcp_f32 v15, v15
    s_waitcnt lgkmcnt(0)
    v_pk_add_f32 v[20:21], v[20:21], v[36:37]
    v_pk_add_f32 v[22:23], v[22:23], v[38:39]
    v_pk_add_f32 v[24:25], v[24:25], v[40:41]
    v_pk_add_f32 v[26:27], v[26:27], v[42:43]
    v_mov_b32 v14, v15
    v_pk_mul_f32 v[16:17], v[16:17], v[14:15]
    v_pk_mul_f32 v[18:19], v[18:19], v[14:15]
    v_cvt_pk_bf16_f32 v32, v16, v17
    v_cvt_pk_bf16_f32 v33, v18, v19
    v_pk_mul_f32 v[20:21], v[20:21], v[14:15]
    v_pk_mul_f32 v[22:23], v[22:23], v[14:15]
    v_cvt_pk_bf16_f32 v34, v20, v21
    v_cvt_pk_bf16_f32 v35, v22, v23
    v_pk_mul_f32 v[24:25], v[24:25], v[14:15]
    v_pk_mul_f32 v[26:27], v[26:27], v[14:15]
    v_cvt_pk_bf16_f32 v36, v24, v25
    v_cvt_pk_bf16_f32 v37, v26, v27
    v_pk_mul_f32 v[28:29], v[28:29], v[14:15]
    v_pk_mul_f32 v[30:31], v[30:31], v[14:15]
    v_cvt_pk_bf16_f32 v38, v28, v29
    v_cvt_pk_bf16_f32 v39, v30, v31
    s_bitcmp1_b32 s57, 0
    s_cbranch_scc1 ZF_54
    v_cndmask_b32 v38, v38, 0, s[20:21]
    v_cndmask_b32 v39, v39, 0, s[20:21]
    s_branch ZF_55
ZF_54:
    v_cndmask_b32 v32, 0, v32, s[20:21]
    v_cndmask_b32 v33, 0, v33, s[20:21]
ZF_55:
    s_nop 0
    v_permlane32_swap_b32 v32, v34
    v_permlane32_swap_b32 v33, v35
    v_permlane32_swap_b32 v36, v38
    v_permlane32_swap_b32 v37, v39
    s_cmp_eq_u32 s62, 1
    s_cbranch_scc0 SL_56
    buffer_store_dwordx4 v[32:35], v10, s[52:55], 0 offen offset:0
    buffer_store_dwordx4 v[36:39], v10, s[52:55], 0 offen offset:1024
    s_branch SL_57
SL_56:
    buffer_store_dwordx4 v[32:35], v10, s[52:55], 0 offen offset:0 sc1
    buffer_store_dwordx4 v[36:39], v10, s[52:55], 0 offen offset:1024 sc1
SL_57:
    s_and_b32 s64, s58, 1
    s_bfe_u32 s65, s58, 0x10001
    s_lshl_b32 s66, s56, 2
    s_lshl_b32 s4, s97, 1
    s_add_u32 s66, s66, s4
    s_lshl_b32 s3, s60, 1
    s_add_u32 s67, s3, s64
    s_lshl_b32 s3, s67, 8
    s_add_u32 s5, s66, s65
    s_add_u32 s3, s3, s5
    s_lshl_b32 s69, s3, 11
    s_add_u32 s69, s69, 6291456
    s_lshl_b32 s3, s5, 7
    s_lshl_b32 s4, s67, 5
    s_add_u32 s3, s3, s4
    s_add_u32 s68, s3, 33570816
    s_mov_b64 exec, 1
    s_waitcnt vmcnt(0)
    s_cmp_eq_u32 s62, 1
    s_cbranch_scc0 SL_58
    buffer_store_dwordx2 v[60:61], v13, s[52:55], 0 offen
    s_branch SL_59
SL_58:
    buffer_store_dwordx2 v[60:61], v13, s[52:55], 0 offen sc1
SL_59:
    s_mov_b64 exec, -1
    s_branch MG_53
MG_52:
    s_and_b32 s64, s58, 1
    s_bfe_u32 s65, s58, 0x10001
    s_lshl_b32 s66, s56, 2
    s_lshl_b32 s4, s97, 1
    s_add_u32 s66, s66, s4
    s_lshl_b32 s3, s60, 1
    s_add_u32 s67, s3, s64
    s_lshl_b32 s3, s67, 8
    s_add_u32 s5, s66, s65
    s_add_u32 s3, s3, s5
    s_lshl_b32 s69, s3, 11
    s_add_u32 s69, s69, 6291456
    s_lshl_b32 s3, s5, 7
    s_lshl_b32 s4, s67, 5
    s_add_u32 s3, s3, s4
    s_add_u32 s68, s3, 33570816
    s_cmp_eq_u32 s17, 0
    s_cbranch_scc1 NB_60
    v_mov_b32 v4, v232
    v_mov_b32 v5, v233
    v_mov_b32 v6, v234
    v_mov_b32 v7, v235
    v_mov_b32 v8, v236
    v_mov_b32 v9, v237
    v_mov_b32 v10, v238
    v_mov_b32 v11, v239
    s_and_b32 s100, s58, 1
    s_lshl_b32 s100, s100, 6
    s_lshr_b32 s3, s59, 1
    s_mul_i32 s3, s3, 57344
    v_lshrrev_b32 v14, 5, v1
    v_lshlrev_b32 v14, 9, v14
    v_bfe_u32 v15, v1, 2, 2
    v_lshl_add_u32 v14, v15, 7, v14
    v_bfe_u32 v15, v1, 4, 1
    v_lshl_add_u32 v14, v15, 5, v14
    v_and_b32 v15, 3, v1
    v_lshl_add_u32 v14, v15, 3, v14
    v_bfe_u32 v15, v1, 3, 1
    v_lshlrev_b32 v15, 6, v15
    v_xor_b32 v15, s100, v15
    v_add_u32 v14, v14, v15
    v_add_u32 v3, s3, v14
    ds_read_b64_tr_b16 v[144:145], v3 offset:0
    ds_read_b64_tr_b16 v[146:147], v3 offset:1024
    ds_read_b64_tr_b16 v[148:149], v3 offset:2048
    ds_read_b64_tr_b16 v[150:151], v3 offset:3072
    ds_read_b64_tr_b16 v[152:153], v3 offset:4096
    ds_read_b64_tr_b16 v[154:155], v3 offset:5120
    ds_read_b64_tr_b16 v[156:157], v3 offset:6144
    ds_read_b64_tr_b16 v[158:159], v3 offset:7168
    ds_read_b64_tr_b16 v[160:161], v3 offset:8192
    ds_read_b64_tr_b16 v[162:163], v3 offset:9216
    ds_read_b64_tr_b16 v[164:165], v3 offset:10240
    ds_read_b64_tr_b16 v[166:167], v3 offset:11264
    ds_read_b64_tr_b16 v[168:169], v3 offset:12288
    ds_read_b64_tr_b16 v[170:171], v3 offset:13312
    ds_read_b64_tr_b16 v[172:173], v3 offset:14336
    ds_read_b64_tr_b16 v[174:175], v3 offset:15360
    ds_read_b64_tr_b16 v[176:177], v3 offset:16384
    ds_read_b64_tr_b16 v[178:179], v3 offset:17408
    ds_read_b64_tr_b16 v[180:181], v3 offset:18432
    ds_read_b64_tr_b16 v[182:183], v3 offset:19456
    ds_read_b64_tr_b16 v[184:185], v3 offset:20480
    ds_read_b64_tr_b16 v[186:187], v3 offset:21504
    ds_read_b64_tr_b16 v[188:189], v3 offset:22528
    ds_read_b64_tr_b16 v[190:191], v3 offset:23552
    ds_read_b64_tr_b16 v[192:193], v3 offset:24576
    ds_read_b64_tr_b16 v[194:195], v3 offset:25600
    ds_read_b64_tr_b16 v[196:197], v3 offset:26624
    ds_read_b64_tr_b16 v[198:199], v3 offset:27648
    ds_read_b64_tr_b16 v[200:201], v3 offset:28672
    ds_read_b64_tr_b16 v[202:203], v3 offset:29696
    ds_read_b64_tr_b16 v[204:205], v3 offset:30720
    ds_read_b64_tr_b16 v[206:207], v3 offset:31744
    ds_read_b64_tr_b16 v[208:209], v3 offset:32768
    ds_read_b64_tr_b16 v[210:211], v3 offset:33792
    ds_read_b64_tr_b16 v[212:213], v3 offset:34816
    ds_read_b64_tr_b16 v[214:215], v3 offset:35840
    ds_read_b64_tr_b16 v[216:217], v3 offset:36864
    ds_read_b64_tr_b16 v[218:219], v3 offset:37888
    ds_read_b64_tr_b16 v[220:221], v3 offset:38912
    ds_read_b64_tr_b16 v[222:223], v3 offset:39936
    ds_read_b64_tr_b16 v[224:225], v3 offset:40960
    ds_read_b64_tr_b16 v[226:227], v3 offset:41984
    ds_read_b64_tr_b16 v[228:229], v3 offset:43008
    ds_read_b64_tr_b16 v[230:231], v3 offset:44032
    ds_read_b64_tr_b16 v[232:233], v3 offset:45056
    ds_read_b64_tr_b16 v[234:235], v3 offset:46080
    ds_read_b64_tr_b16 v[236:237], v3 offset:47104
    ds_read_b64_tr_b16 v[238:239], v3 offset:48128
    ds_read_b64_tr_b16 v[240:241], v3 offset:49152
    ds_read_b64_tr_b16 v[242:243], v3 offset:50176
    ds_read_b64_tr_b16 v[244:245], v3 offset:51200
    ds_read_b64_tr_b16 v[246:247], v3 offset:52224
    ds_read_b64_tr_b16 v[248:249], v3 offset:53248
    ds_read_b64_tr_b16 v[250:251], v3 offset:54272
    ds_read_b64_tr_b16 v[252:253], v3 offset:55296
    ds_read_b64_tr_b16 v[254:255], v3 offset:56320
NB_60:
MG_53:
    s_cmp_eq_u32 s17, 1
    s_cbranch_scc1 BZ_61
    s_and_b32 s3, s56, 1
    s_lshl_b32 s3, s3, 1
    s_add_u32 s3, s3, s57
    s_sub_u32 s3, s3, 14
    s_mul_i32 s3, s3, 401408
    s_mul_i32 s4, s58, 7168
    s_add_u32 s3, s3, s4
    v_lshl_add_u32 v21, v1, 7, s3
    v_mul_u32_u24 v22, 147, v1
    v_lshrrev_b32 v22, 10, v22
    v_mul_u32_u24 v22, 7, v22
    v_sub_u32 v22, v1, v22
    v_mov_b32 v22, 0
    s_waitcnt vmcnt(0)
    s_barrier
    s_mov_b32 exec_lo, 0xffffffff
    s_mov_b32 exec_hi, 0xffffff
    v_add_u32 v23, 0, v22
    v_subrev_u32 v24, 7, v23
    v_min_u32 v23, v23, v24
    v_mul_u32_u24 v23, 57344, v23
    v_add_u32 v23, v23, v21
    buffer_load_dword v86, v23, s[40:43], 0 offen
    v_add_u32 v23, 1, v22
    v_subrev_u32 v24, 7, v23
    v_min_u32 v23, v23, v24
    v_mul_u32_u24 v23, 57344, v23
    v_add_u32 v23, v23, v21
    buffer_load_dword v86, v23, s[40:43], 0 offen
    v_add_u32 v23, 3, v22
    v_subrev_u32 v24, 7, v23
    v_min_u32 v23, v23, v24
    v_mul_u32_u24 v23, 57344, v23
    v_add_u32 v23, v23, v21
    buffer_load_dword v86, v23, s[40:43], 0 offen
    v_add_u32 v23, 4, v22
    v_subrev_u32 v24, 7, v23
    v_min_u32 v23, v23, v24
    v_mul_u32_u24 v23, 57344, v23
    v_add_u32 v23, v23, v21
    buffer_load_dword v86, v23, s[40:43], 0 offen
    v_add_u32 v23, 2, v22
    v_subrev_u32 v24, 7, v23
    v_min_u32 v23, v23, v24
    v_mul_u32_u24 v23, 57344, v23
    v_add_u32 v23, v23, v21
    buffer_load_dword v86, v23, s[40:43], 0 offen
    v_add_u32 v23, 5, v22
    v_subrev_u32 v24, 7, v23
    v_min_u32 v23, v23, v24
    v_mul_u32_u24 v23, 57344, v23
    v_add_u32 v23, v23, v21
    buffer_load_dword v86, v23, s[40:43], 0 offen
    v_add_u32 v23, 6, v22
    v_subrev_u32 v24, 7, v23
    v_min_u32 v23, v23, v24
    v_mul_u32_u24 v23, 57344, v23
    v_add_u32 v23, v23, v21
    buffer_load_dword v86, v23, s[40:43], 0 offen
    s_mov_b64 exec, -1
    s_branch L_FIN
BZ_61:
    v_lshlrev_b32 v2, 4, v1
    v_lshl_add_u32 v13, v1, 3, s68
    s_mov_b32 exec_lo, 0xf
    s_mov_b32 exec_hi, 0x0
    s_mov_b32 s22, 200000
    s_nop 15
POLLO_62:
    buffer_load_dwordx2 v[14:15], v13, s[52:55], 0 offen sc1
    s_waitcnt vmcnt(0)
    v_xor_b32 v12, s1, v15
    v_and_b32 v12, 0xfffffff, v12
    v_xor_b32 v14, s0, v14
    v_or_b32 v12, v12, v14
    v_cmp_ne_u32 vcc, 0, v12
    s_sub_u32 s22, s22, 1
    s_cbranch_scc1 PDONEO_63
    s_nop 2
    s_cbranch_vccz PDONEO_63
    s_mov_b64 exec, vcc
    s_branch POLLO_62
PDONEO_63:
    s_mov_b64 exec, -1
    s_add_u32 s3, s69, 0
    buffer_load_dwordx4 v[48:51], v2, s[52:55], s3 offen offset:0 sc1
    buffer_load_dwordx4 v[52:55], v2, s[52:55], s3 offen offset:1024 sc1
    s_add_u32 s3, s69, 131072
    buffer_load_dwordx4 v[56:59], v2, s[52:55], s3 offen offset:0 sc1
    buffer_load_dwordx4 v[60:63], v2, s[52:55], s3 offen offset:1024 sc1
    s_add_u32 s3, s69, 262144
    buffer_load_dwordx4 v[64:67], v2, s[52:55], s3 offen offset:0 sc1
    buffer_load_dwordx4 v[68:71], v2, s[52:55], s3 offen offset:1024 sc1
    s_add_u32 s3, s69, 393216
    buffer_load_dwordx4 v[72:75], v2, s[52:55], s3 offen offset:0 sc1
    buffer_load_dwordx4 v[76:79], v2, s[52:55], s3 offen offset:1024 sc1
    s_cmp_eq_u32 s60, 1
    s_cbranch_scc1 CS0_64
    s_cmp_eq_u32 s17, 0
    s_cbranch_scc1 NB_66
    v_mov_b32 v4, v232
    v_mov_b32 v5, v233
    v_mov_b32 v6, v234
    v_mov_b32 v7, v235
    v_mov_b32 v8, v236
    v_mov_b32 v9, v237
    v_mov_b32 v10, v238
    v_mov_b32 v11, v239
    s_and_b32 s100, s58, 1
    s_lshl_b32 s100, s100, 6
    s_lshr_b32 s3, s59, 1
    s_mul_i32 s3, s3, 57344
    v_lshrrev_b32 v14, 5, v1
    v_lshlrev_b32 v14, 9, v14
    v_bfe_u32 v15, v1, 2, 2
    v_lshl_add_u32 v14, v15, 7, v14
    v_bfe_u32 v15, v1, 4, 1
    v_lshl_add_u32 v14, v15, 5, v14
    v_and_b32 v15, 3, v1
    v_lshl_add_u32 v14, v15, 3, v14
    v_bfe_u32 v15, v1, 3, 1
    v_lshlrev_b32 v15, 6, v15
    v_xor_b32 v15, s100, v15
    v_add_u32 v14, v14, v15
    v_add_u32 v3, s3, v14
    ds_read_b64_tr_b16 v[144:145], v3 offset:0
    ds_read_b64_tr_b16 v[146:147], v3 offset:1024
    ds_read_b64_tr_b16 v[148:149], v3 offset:2048
    ds_read_b64_tr_b16 v[150:151], v3 offset:3072
    ds_read_b64_tr_b16 v[152:153], v3 offset:4096
    ds_read_b64_tr_b16 v[154:155], v3 offset:5120
    ds_read_b64_tr_b16 v[156:157], v3 offset:6144
    ds_read_b64_tr_b16 v[158:159], v3 offset:7168
    ds_read_b64_tr_b16 v[160:161], v3 offset:8192
    ds_read_b64_tr_b16 v[162:163], v3 offset:9216
    ds_read_b64_tr_b16 v[164:165], v3 offset:10240
    ds_read_b64_tr_b16 v[166:167], v3 offset:11264
    ds_read_b64_tr_b16 v[168:169], v3 offset:12288
    ds_read_b64_tr_b16 v[170:171], v3 offset:13312
    ds_read_b64_tr_b16 v[172:173], v3 offset:14336
    ds_read_b64_tr_b16 v[174:175], v3 offset:15360
    ds_read_b64_tr_b16 v[176:177], v3 offset:16384
    ds_read_b64_tr_b16 v[178:179], v3 offset:17408
    ds_read_b64_tr_b16 v[180:181], v3 offset:18432
    ds_read_b64_tr_b16 v[182:183], v3 offset:19456
    ds_read_b64_tr_b16 v[184:185], v3 offset:20480
    ds_read_b64_tr_b16 v[186:187], v3 offset:21504
    ds_read_b64_tr_b16 v[188:189], v3 offset:22528
    ds_read_b64_tr_b16 v[190:191], v3 offset:23552
    ds_read_b64_tr_b16 v[192:193], v3 offset:24576
    ds_read_b64_tr_b16 v[194:195], v3 offset:25600
    ds_read_b64_tr_b16 v[196:197], v3 offset:26624
    ds_read_b64_tr_b16 v[198:199], v3 offset:27648
    ds_read_b64_tr_b16 v[200:201], v3 offset:28672
    ds_read_b64_tr_b16 v[202:203], v3 offset:29696
    ds_read_b64_tr_b16 v[204:205], v3 offset:30720
    ds_read_b64_tr_b16 v[206:207], v3 offset:31744
    ds_read_b64_tr_b16 v[208:209], v3 offset:32768
    ds_read_b64_tr_b16 v[210:211], v3 offset:33792
    ds_read_b64_tr_b16 v[212:213], v3 offset:34816
    ds_read_b64_tr_b16 v[214:215], v3 offset:35840
    ds_read_b64_tr_b16 v[216:217], v3 offset:36864
    ds_read_b64_tr_b16 v[218:219], v3 offset:37888
    ds_read_b64_tr_b16 v[220:221], v3 offset:38912
    ds_read_b64_tr_b16 v[222:223], v3 offset:39936
    ds_read_b64_tr_b16 v[224:225], v3 offset:40960
    ds_read_b64_tr_b16 v[226:227], v3 offset:41984
    ds_read_b64_tr_b16 v[228:229], v3 offset:43008
    ds_read_b64_tr_b16 v[230:231], v3 offset:44032
    ds_read_b64_tr_b16 v[232:233], v3 offset:45056
    ds_read_b64_tr_b16 v[234:235], v3 offset:46080
    ds_read_b64_tr_b16 v[236:237], v3 offset:47104
    ds_read_b64_tr_b16 v[238:239], v3 offset:48128
    ds_read_b64_tr_b16 v[240:241], v3 offset:49152
    ds_read_b64_tr_b16 v[242:243], v3 offset:50176
    ds_read_b64_tr_b16 v[244:245], v3 offset:51200
    ds_read_b64_tr_b16 v[246:247], v3 offset:52224
    ds_read_b64_tr_b16 v[248:249], v3 offset:53248
    ds_read_b64_tr_b16 v[250:251], v3 offset:54272
    ds_read_b64_tr_b16 v[252:253], v3 offset:55296
    ds_read_b64_tr_b16 v[254:255], v3 offset:56320
NB_66:
CS0_64:
    s_lshl_b32 s4, s65, 15
    s_add_u32 s4, s4, 98304
    s_lshl_b32 s3, s67, 11
    s_add_u32 s79, s3, s4
    s_lshl_b32 s3, s67, 13
    s_add_u32 s80, s3, s4
    s_add_u32 s3, s66, s65
    s_mul_i32 s3, s3, 28
    s_lshl_b32 s4, s23, 2
    s_add_u32 s3, s3, s4
    s_lshl_b32 s4, s64, 1
    s_add_u32 s3, s3, s4
    s_add_u32 s3, s3, s60
    s_lshl_b32 s4, s3, 10
    s_add_u32 s81, s4, 8388608
    s_lshl_b32 s4, s3, 8
    s_add_u32 s82, s4, 10485760
    s_and_b32 s71, s58, 2
    s_add_u32 s71, s71, s60
    s_mul_i32 s3, s71, 448
    s_lshl_b32 s5, s64, 4
    s_add_u32 s3, s3, s5
    s_lshl_b32 s5, s23, 7
    v_lshrrev_b32 v14, 3, v1
    v_bfe_u32 v15, v1, 4, 1
    v_lshlrev_b32 v15, 2, v15
    v_xor_b32 v15, v15, v1
    v_and_b32 v15, 7, v15
    v_add_u32 v14, s3, v14
    v_mul_u32_u24 v14, 896, v14
    v_lshl_add_u32 v14, v15, 4, v14
    v_add_u32 v84, s5, v14
    s_lshl_b32 s3, s71, 12
    s_lshl_b32 s4, s64, 11
    s_add_u32 s72, s3, s4
    s_mov_b32 s84, 0
    s_add_u32 s85, s84, 4096
    s_cmp_eq_u32 s85, 28672
    s_cselect_b32 s85, 0, s85
    s_add_u32 s86, s85, 4096
    s_cmp_eq_u32 s86, 28672
    s_cselect_b32 s86, 0, s86
    s_add_u32 s87, s86, 4096
    s_cmp_eq_u32 s87, 28672
    s_cselect_b32 s87, 0, s87
    s_add_u32 s88, s87, 4096
    s_cmp_eq_u32 s88, 28672
    s_cselect_b32 s88, 0, s88
    s_add_u32 s89, s88, 4096
    s_cmp_eq_u32 s89, 28672
    s_cselect_b32 s89, 0, s89
    s_add_u32 s90, s89, 4096
    s_cmp_eq_u32 s90, 28672
    s_cselect_b32 s90, 0, s90
    v_add_u32 v12, s79, v2
    v_add_u32 v13, s80, v2
    v_lshlrev_b32 v3, 2, v1
    s_waitcnt lgkmcnt(0)
    s_barrier
    s_waitcnt vmcnt(7)
    v_mfma_f32_32x32x16_bf16 v[16:31], v[88:91], v[48:51], 0
    v_mfma_f32_32x32x16_bf16 v[32:47], v[92:95], v[48:51], 0
    s_waitcnt vmcnt(6)
    v_mfma_f32_32x32x16_bf16 v[16:31], v[96:99], v[52:55], v[16:31]
    v_mfma_f32_32x32x16_bf16 v[32:47], v[100:103], v[52:55], v[32:47]
    s_waitcnt vmcnt(5)
    v_mfma_f32_32x32x16_bf16 v[16:31], v[104:107], v[56:59], v[16:31]
    v_mfma_f32_32x32x16_bf16 v[32:47], v[108:111], v[56:59], v[32:47]
    s_waitcnt vmcnt(4)
    v_mfma_f32_32x32x16_bf16 v[16:31], v[112:115], v[60:63], v[16:31]
    v_mfma_f32_32x32x16_bf16 v[32:47], v[116:119], v[60:63], v[32:47]
    s_waitcnt vmcnt(3)
    v_mfma_f32_32x32x16_bf16 v[16:31], v[120:123], v[64:67], v[16:31]
    v_mfma_f32_32x32x16_bf16 v[32:47], v[124:127], v[64:67], v[32:47]
    s_waitcnt vmcnt(2)
    v_mfma_f32_32x32x16_bf16 v[16:31], v[128:131], v[68:71], v[16:31]
    v_mfma_f32_32x32x16_bf16 v[32:47], v[132:135], v[68:71], v[32:47]
    s_waitcnt vmcnt(1)
    v_mfma_f32_32x32x16_bf16 v[16:31], v[136:139], v[72:75], v[16:31]
    v_mfma_f32_32x32x16_bf16 v[32:47], v[140:143], v[72:75], v[32:47]
    s_waitcnt vmcnt(0)
    v_mfma_f32_32x32x16_bf16 v[16:31], v[4:7], v[76:79], v[16:31]
    v_mfma_f32_32x32x16_bf16 v[32:47], v[8:11], v[76:79], v[32:47]
    v_lshlrev_b32 v48, 16, v80
    v_and_b32 v49, 0xffff0000, v80
    v_lshlrev_b32 v50, 16, v81
    v_and_b32 v51, 0xffff0000, v81
    v_lshlrev_b32 v52, 16, v82
    v_and_b32 v53, 0xffff0000, v82
    v_lshlrev_b32 v54, 16, v83
    v_and_b32 v55, 0xffff0000, v83
    v_mov_b32 v8, v84
    v_add_u32 v4, 6144, v84
    s_nop 0
    ds_write_b128 v12, v[16:19] offset:0
    ds_write_b128 v12, v[20:23] offset:1024
    ds_write_b128 v12, v[32:35] offset:8192
    ds_write_b128 v12, v[36:39] offset:9216
    ds_write_b128 v12, v[24:27] offset:16384
    ds_write_b128 v12, v[28:31] offset:17408
    ds_write_b128 v12, v[40:43] offset:24576
    ds_write_b128 v12, v[44:47] offset:25600
    s_mul_i32 s4, s84, 14
    s_add_u32 m0, s72, 32768
    s_nop 0
    buffer_load_dwordx4 v8, s[40:43], s4 offen lds
    buffer_load_dwordx4 v4, s[40:43], s4 offen offset:1024 lds
    s_mul_i32 s4, s84, 14
    s_add_u32 s4, s4, 28672
    s_add_u32 m0, s72, 49152
    s_nop 0
    buffer_load_dwordx4 v8, s[40:43], s4 offen lds
    buffer_load_dwordx4 v4, s[40:43], s4 offen offset:1024 lds
    s_mul_i32 s4, s85, 14
    s_add_u32 m0, s72, 65536
    s_nop 0
    buffer_load_dwordx4 v8, s[40:43], s4 offen lds
    buffer_load_dwordx4 v4, s[40:43], s4 offen offset:1024 lds
    s_waitcnt lgkmcnt(0)
    s_barrier
    ds_read_b128 v[16:19], v13 offset:0
    ds_read_b128 v[20:23], v13 offset:1024
    ds_read_b128 v[24:27], v13 offset:2048
    ds_read_b128 v[28:31], v13 offset:3072
    ds_read_b128 v[32:35], v13 offset:4096
    ds_read_b128 v[36:39], v13 offset:5120
    ds_read_b128 v[40:43], v13 offset:6144
    ds_read_b128 v[44:47], v13 offset:7168
    s_waitcnt lgkmcnt(6)
    v_pk_add_f32 v[48:49], v[48:49], v[16:17]
    v_pk_add_f32 v[50:51], v[50:51], v[18:19]
    v_pk_add_f32 v[52:53], v[52:53], v[20:21]
    v_pk_add_f32 v[54:55], v[54:55], v[22:23]
    s_waitcnt lgkmcnt(2)
    v_pk_add_f32 v[24:25], v[24:25], v[32:33]
    v_pk_add_f32 v[26:27], v[26:27], v[34:35]
    v_pk_add_f32 v[28:29], v[28:29], v[36:37]
    v_pk_add_f32 v[30:31], v[30:31], v[38:39]
    s_waitcnt lgkmcnt(0)
    v_pk_add_f32 v[48:49], v[48:49], v[40:41]
    v_pk_add_f32 v[50:51], v[50:51], v[42:43]
    v_pk_add_f32 v[52:53], v[52:53], v[44:45]
    v_pk_add_f32 v[54:55], v[54:55], v[46:47]
    v_pk_add_f32 v[48:49], v[48:49], v[24:25]
    v_pk_add_f32 v[50:51], v[50:51], v[26:27]
    v_pk_add_f32 v[52:53], v[52:53], v[28:29]
    v_pk_add_f32 v[54:55], v[54:55], v[30:31]
    v_cvt_pk_bf16_f32 v80, v48, v49
    v_cvt_pk_bf16_f32 v81, v50, v51
    v_cvt_pk_bf16_f32 v82, v52, v53
    v_cvt_pk_bf16_f32 v83, v54, v55
    buffer_store_dwordx4 v[80:83], v2, s[52:55], s81 offen sc1
    v_pk_add_f32 v[56:57], v[48:49], v[50:51]
    v_pk_mul_f32 v[58:59], v[48:49], v[48:49]
    v_pk_add_f32 v[60:61], v[52:53], v[54:55]
    v_pk_fma_f32 v[58:59], v[50:51], v[50:51], v[58:59]
    v_pk_add_f32 v[56:57], v[56:57], v[60:61]
    v_pk_fma_f32 v[58:59], v[52:53], v[52:53], v[58:59]
    v_add_f32 v56, v56, v57
    v_pk_fma_f32 v[58:59], v[54:55], v[54:55], v[58:59]
    v_add_f32 v57, v58, v59
    s_nop 1
    v_permlane32_swap_b32 v56, v57
    v_add_f32 v56, v56, v57
    buffer_store_dword v56, v3, s[52:55], s82 offen sc1
    s_lshl_b32 s3, s71, 12
    s_lshl_b32 s100, s64, 6
    v_lshrrev_b32 v14, 5, v1
    v_lshlrev_b32 v14, 9, v14
    v_bfe_u32 v15, v1, 2, 2
    v_lshl_add_u32 v14, v15, 7, v14
    v_bfe_u32 v15, v1, 4, 1
    v_lshl_add_u32 v14, v15, 5, v14
    v_and_b32 v15, 3, v1
    v_lshl_add_u32 v14, v15, 3, v14
    v_bfe_u32 v15, v1, 3, 1
    v_lshlrev_b32 v15, 6, v15
    v_xor_b32 v15, s100, v15
    v_add_u32 v14, v14, v15
    v_add_u32 v9, s3, v14
    v_add_u32 v10, 65536, v9
    s_lshl_b32 s3, s56, 2
    s_lshl_b32 s4, s60, 1
    s_add_u32 s3, s3, s4
    s_mul_i32 s5, s3, 28672
    s_lshl_b32 s4, s59, 11
    s_add_u32 s5, s5, s4
    s_add_u32 s5, s5, 8388608
    v_add_u32 v3, s5, v2
    s_lshl_b32 s73, s58, 11
    s_mul_i32 s3, s3, 112
    s_lshl_b32 s4, s57, 3
    s_add_u32 s3, s3, s4
    s_lshl_b32 s4, s59, 1
    s_add_u32 s3, s3, s4
    s_lshl_b32 s3, s3, 10
    s_add_u32 s3, s3, 16777216
    v_add_u32 v7, s3, v2
    v_add_u32 v11, 114688, v7
    s_lshl_b32 s3, s56, 2
    s_add_u32 s3, s3, s59
    s_mul_i32 s3, s3, 28
    s_mul_i32 s4, s60, 14
    s_add_u32 s3, s3, s4
    s_lshl_b32 s3, s3, 8
    s_add_u32 s74, s3, 10485760
    s_lshl_b32 s3, s60, 13
    v_add_u32 v5, s3, v2
    v_add_u32 v6, 114688, v5
    s_lshl_b32 s3, s56, 11
    s_add_u32 s3, s3, 33603584
    s_lshl_b32 s4, s97, 9
    s_add_u32 s76, s3, s4
    s_lshl_b32 s4, s60, 9
    s_add_u32 s3, s3, s4
    s_lshl_b32 s4, s57, 5
    s_add_u32 s3, s3, s4
    s_lshl_b32 s4, s59, 3
    s_add_u32 s75, s3, s4
    s_lshl_b32 s77, s61, 28
    s_or_b32 s77, s77, s1
    s_mul_i32 s3, s66, 112
    s_mul_i32 s5, s71, 28
    s_add_u32 s3, s3, s5
    s_lshl_b32 s4, s64, 1
    s_add_u32 s3, s3, s4
    s_lshl_b32 s3, s3, 10
    s_add_u32 s78, s3, 16777216
    v_lshrrev_b32 v14, 5, v1
    v_lshl_add_u32 v85, v14, 3, v85
    s_lshl_b32 s4, s56, 7
    s_lshl_b32 s5, s57, 3
    s_add_u32 s4, s4, s5
    s_add_u32 s4, s4, 33587200
    s_lshl_b32 s5, s61, 28
    s_or_b32 s5, s5, s1
    v_mov_b32 v13, s4
    v_mov_b32 v14, s0
    v_mov_b32 v15, s5
    s_waitcnt vmcnt(0) lgkmcnt(0)
    s_barrier
    s_cmp_lg_u32 s58, 0
    s_cbranch_scc1 PUB_67
    s_mov_b64 exec, 1
    s_cmp_eq_u32 s62, 1
    s_cbranch_scc0 SL_68
    buffer_store_dwordx2 v[14:15], v13, s[52:55], 0 offen
    s_branch SL_69
SL_68:
    buffer_store_dwordx2 v[14:15], v13, s[52:55], 0 offen sc1
SL_69:
    s_mov_b64 exec, -1
PUB_67:
    s_cmp_eq_u32 s60, 1
    s_cbranch_scc1 CS0_70
    v_mov_b32 v86, 0
    s_waitcnt lgkmcnt(0)
    v_dot2c_f32_bf16 v86, s96, v144
    v_dot2c_f32_bf16 v86, s96, v145
    v_dot2c_f32_bf16 v86, s96, v146
    v_dot2c_f32_bf16 v86, s96, v147
    v_dot2c_f32_bf16 v86, s96, v148
    v_dot2c_f32_bf16 v86, s96, v149
    v_dot2c_f32_bf16 v86, s96, v150
    v_dot2c_f32_bf16 v86, s96, v151
    v_dot2c_f32_bf16 v86, s96, v152
    v_dot2c_f32_bf16 v86, s96, v153
    v_dot2c_f32_bf16 v86, s96, v154
    v_dot2c_f32_bf16 v86, s96, v155
    v_dot2c_f32_bf16 v86, s96, v156
    v_dot2c_f32_bf16 v86, s96, v157
    v_dot2c_f32_bf16 v86, s96, v158
    v_dot2c_f32_bf16 v86, s96, v159
    v_dot2c_f32_bf16 v86, s96, v160
    v_dot2c_f32_bf16 v86, s96, v161
    v_dot2c_f32_bf16 v86, s96, v162
    v_dot2c_f32_bf16 v86, s96, v163
    v_dot2c_f32_bf16 v86, s96, v164
    v_dot2c_f32_bf16 v86, s96, v165
    v_dot2c_f32_bf16 v86, s96, v166
    v_dot2c_f32_bf16 v86, s96, v167
    v_dot2c_f32_bf16 v86, s96, v168
    v_dot2c_f32_bf16 v86, s96, v169
    v_dot2c_f32_bf16 v86, s96, v170
    v_dot2c_f32_bf16 v86, s96, v171
    v_dot2c_f32_bf16 v86, s96, v172
    v_dot2c_f32_bf16 v86, s96, v173
    v_dot2c_f32_bf16 v86, s96, v174
    v_dot2c_f32_bf16 v86, s96, v175
    v_dot2c_f32_bf16 v86, s96, v176
    v_dot2c_f32_bf16 v86, s96, v177
    v_dot2c_f32_bf16 v86, s96, v178
    v_dot2c_f32_bf16 v86, s96, v179
    v_dot2c_f32_bf16 v86, s96, v180
    v_dot2c_f32_bf16 v86, s96, v181
    v_dot2c_f32_bf16 v86, s96, v182
    v_dot2c_f32_bf16 v86, s96, v183
    v_dot2c_f32_bf16 v86, s96, v184
    v_dot2c_f32_bf16 v86, s96, v185
    v_dot2c_f32_bf16 v86, s96, v186
    v_dot2c_f32_bf16 v86, s96, v187
    v_dot2c_f32_bf16 v86, s96, v188
    v_dot2c_f32_bf16 v86, s96, v189
    v_dot2c_f32_bf16 v86, s96, v190
    v_dot2c_f32_bf16 v86, s96, v191
    v_dot2c_f32_bf16 v86, s96, v192
    v_dot2c_f32_bf16 v86, s96, v193
    v_dot2c_f32_bf16 v86, s96, v194
    v_dot2c_f32_bf16 v86, s96, v195
    v_dot2c_f32_bf16 v86, s96, v196
    v_dot2c_f32_bf16 v86, s96, v197
    v_dot2c_f32_bf16 v86, s96, v198
    v_dot2c_f32_bf16 v86, s96, v199
    s_branch CS0_71
CS0_70:
    v_mov_b32 v86, 0
    s_waitcnt lgkmcnt(0)
    v_dot2c_f32_bf16 v86, s96, v200
    v_dot2c_f32_bf16 v86, s96, v201
    v_dot2c_f32_bf16 v86, s96, v202
    v_dot2c_f32_bf16 v86, s96, v203
    v_dot2c_f32_bf16 v86, s96, v204
    v_dot2c_f32_bf16 v86, s96, v205
    v_dot2c_f32_bf16 v86, s96, v206
    v_dot2c_f32_bf16 v86, s96, v207
    v_dot2c_f32_bf16 v86, s96, v208
    v_dot2c_f32_bf16 v86, s96, v209
    v_dot2c_f32_bf16 v86, s96, v210
    v_dot2c_f32_bf16 v86, s96, v211
    v_dot2c_f32_bf16 v86, s96, v212
    v_dot2c_f32_bf16 v86, s96, v213
    v_dot2c_f32_bf16 v86, s96, v214
    v_dot2c_f32_bf16 v86, s96, v215
    v_dot2c_f32_bf16 v86, s96, v216
    v_dot2c_f32_bf16 v86, s96, v217
    v_dot2c_f32_bf16 v86, s96, v218
    v_dot2c_f32_bf16 v86, s96, v219
    v_dot2c_f32_bf16 v86, s96, v220
    v_dot2c_f32_bf16 v86, s96, v221
    v_dot2c_f32_bf16 v86, s96, v222
    v_dot2c_f32_bf16 v86, s96, v223
    v_dot2c_f32_bf16 v86, s96, v224
    v_dot2c_f32_bf16 v86, s96, v225
    v_dot2c_f32_bf16 v86, s96, v226
    v_dot2c_f32_bf16 v86, s96, v227
    v_dot2c_f32_bf16 v86, s96, v228
    v_dot2c_f32_bf16 v86, s96, v229
    v_dot2c_f32_bf16 v86, s96, v230
    v_dot2c_f32_bf16 v86, s96, v231
    v_dot2c_f32_bf16 v86, s96, v232
    v_dot2c_f32_bf16 v86, s96, v233
    v_dot2c_f32_bf16 v86, s96, v234
    v_dot2c_f32_bf16 v86, s96, v235
    v_dot2c_f32_bf16 v86, s96, v236
    v_dot2c_f32_bf16 v86, s96, v237
    v_dot2c_f32_bf16 v86, s96, v238
    v_dot2c_f32_bf16 v86, s96, v239
    v_dot2c_f32_bf16 v86, s96, v240
    v_dot2c_f32_bf16 v86, s96, v241
    v_dot2c_f32_bf16 v86, s96, v242
    v_dot2c_f32_bf16 v86, s96, v243
    v_dot2c_f32_bf16 v86, s96, v244
    v_dot2c_f32_bf16 v86, s96, v245
    v_dot2c_f32_bf16 v86, s96, v246
    v_dot2c_f32_bf16 v86, s96, v247
    v_dot2c_f32_bf16 v86, s96, v248
    v_dot2c_f32_bf16 v86, s96, v249
    v_dot2c_f32_bf16 v86, s96, v250
    v_dot2c_f32_bf16 v86, s96, v251
    v_dot2c_f32_bf16 v86, s96, v252
    v_dot2c_f32_bf16 v86, s96, v253
    v_dot2c_f32_bf16 v86, s96, v254
    v_dot2c_f32_bf16 v86, s96, v255
CS0_71:
    v_lshlrev_b32 v14, 2, v0
    v_add_u32 v14, 155648, v14
    s_nop 0
    ds_write_b32 v14, v86
    v_xor_b32 v76, 1024, v14
    s_cmp_lg_u32 s58, 1
    s_cbranch_scc1 PG_72
    s_lshl_b32 s3, s56, 7
    s_add_u32 s3, s3, 33587200
    v_lshl_add_u32 v13, v1, 3, s3
    s_mov_b32 exec_lo, 0x3fff
    s_mov_b32 exec_hi, 0x0
    s_mov_b32 s22, 200000
    s_nop 15
POLLH_73:
    buffer_load_dwordx2 v[14:15], v13, s[52:55], 0 offen sc1
    s_waitcnt vmcnt(0)
    v_xor_b32 v12, s1, v15
    v_and_b32 v12, 0xfffffff, v12
    v_xor_b32 v14, s0, v14
    v_or_b32 v12, v12, v14
    v_cmp_ne_u32 vcc, 0, v12
    s_sub_u32 s22, s22, 1
    s_cbranch_scc1 PDONEH_74
    s_nop 2
    s_cbranch_vccz PDONEH_74
    s_mov_b64 exec, vcc
    s_branch POLLH_73
PDONEH_74:
    s_mov_b64 exec, -1
PG_72:
    s_waitcnt lgkmcnt(0)
    s_barrier
    s_mov_b32 s3, 0
    s_add_u32 m0, s73, 0
    s_nop 0
    buffer_load_dwordx4 v3, s[52:55], s3 offen sc1 lds
    buffer_load_dwordx4 v3, s[52:55], s3 offen offset:1024 sc1 lds
    s_mov_b32 s3, 8192
    s_add_u32 m0, s73, 16384
    s_nop 0
    buffer_load_dwordx4 v3, s[52:55], s3 offen sc1 lds
    buffer_load_dwordx4 v3, s[52:55], s3 offen offset:1024 sc1 lds
    s_mov_b32 s3, 16384
    s_add_u32 m0, s73, 114688
    s_nop 0
    buffer_load_dwordx4 v3, s[52:55], s3 offen sc1 lds
    buffer_load_dwordx4 v3, s[52:55], s3 offen offset:1024 sc1 lds
    ds_read_b32 v77, v76
    s_lshl_b32 s3, s60, 11
    s_add_u32 s3, s3, 147456
    v_lshl_add_u32 v12, v1, 2, s3
    s_lshl_b32 s3, s97, 1
    s_add_u32 s3, s3, s65
    s_lshl_b32 s3, s3, 10
    s_add_u32 s3, s3, 147456
    v_lshl_add_u32 v13, v1, 2, s3
    s_waitcnt lgkmcnt(0)
    v_add_f32 v86, v86, v77
    v_mov_b32 v14, v86
    s_nop 1
    v_permlane32_swap_b32 v14, v86
    v_add_f32 v86, v86, v14
    v_cndmask_b32 v86, v86, 0, s[20:21]
    v_cvt_pk_bf16_f32 v77, v86, 0
    v_lshlrev_b32 v78, 16, v77
    v_sub_f32 v78, v86, v78
    v_cvt_pk_bf16_f32 v76, v86, v78
    v_mov_b32 v78, 0
    v_mov_b32 v79, 0
    s_waitcnt vmcnt(4)
    s_barrier
    ds_read_b128 v[48:51], v5 offset:0
    ds_read_b128 v[52:55], v5 offset:1024
    ds_read_b128 v[56:59], v5 offset:2048
    ds_read_b128 v[60:63], v5 offset:3072
    ds_read_b128 v[64:67], v5 offset:4096
    ds_read_b128 v[68:71], v5 offset:5120
    s_waitcnt lgkmcnt(5)
    v_mfma_f32_32x32x16_bf16 v[16:31], v[144:147], v[48:51], 0
    ds_read_b128 v[48:51], v5 offset:6144
    buffer_load_dwordx4 v[128:131], v2, s[52:55], s74 offen offset:0 sc1
    buffer_load_dwordx4 v[132:135], v2, s[52:55], s74 offen offset:1024 sc1
    s_waitcnt lgkmcnt(5)
    v_mfma_f32_32x32x16_bf16 v[16:31], v[148:151], v[52:55], v[16:31]
    ds_read_b128 v[52:55], v5 offset:7168
    buffer_load_dwordx4 v[136:139], v2, s[52:55], s74 offen offset:2048 sc1
    buffer_load_dwordx4 v[140:143], v2, s[52:55], s74 offen offset:3072 sc1
    s_waitcnt lgkmcnt(5)
    v_mfma_f32_32x32x16_bf16 v[16:31], v[152:155], v[56:59], v[16:31]
    s_waitcnt vmcnt(6)
    s_barrier
    ds_read_b128 v[56:59], v5 offset:16384
    s_waitcnt lgkmcnt(5)
    v_mfma_f32_32x32x16_bf16 v[16:31], v[156:159], v[60:63], v[16:31]
    ds_read_b128 v[60:63], v5 offset:17408
    ds_read_b64_tr_b16 v[88:89], v9 offset:32768
    ds_read_b64_tr_b16 v[90:91], v9 offset:33792
    s_mov_b32 s3, 24576
    s_add_u32 m0, s73, 131072
    s_nop 0
    buffer_load_dwordx4 v3, s[52:55], s3 offen sc1 lds
    s_waitcnt lgkmcnt(7)
    v_mfma_f32_32x32x16_bf16 v[16:31], v[160:163], v[64:67], v[16:31]
    ds_read_b128 v[64:67], v5 offset:18432
    ds_read_b64_tr_b16 v[92:93], v9 offset:34816
    ds_read_b64_tr_b16 v[94:95], v9 offset:35840
    s_add_u32 m0, s73, 131072
    s_nop 0
    buffer_load_dwordx4 v3, s[52:55], s3 offen offset:1024 sc1 lds
    s_waitcnt lgkmcnt(9)
    v_mfma_f32_32x32x16_bf16 v[16:31], v[164:167], v[68:71], v[16:31]
    ds_read_b128 v[68:71], v5 offset:19456
    s_waitcnt lgkmcnt(9)
    v_mfma_f32_32x32x16_bf16 v[16:31], v[168:171], v[48:51], v[16:31]
    ds_read_b128 v[48:51], v5 offset:20480
    s_waitcnt lgkmcnt(9)
    v_mfma_f32_32x32x16_bf16 v[16:31], v[172:175], v[52:55], v[16:31]
    ds_read_b128 v[52:55], v5 offset:21504
    s_waitcnt lgkmcnt(9)
    v_mfma_f32_32x32x16_bf16 v[16:31], v[176:179], v[56:59], v[16:31]
    ds_read_b128 v[56:59], v5 offset:22528
    s_waitcnt lgkmcnt(9)
    v_mfma_f32_32x32x16_bf16 v[16:31], v[180:183], v[60:63], v[16:31]
    ds_read_b128 v[60:63], v5 offset:23552
    s_waitcnt lgkmcnt(7)
    v_mfma_f32_32x32x16_bf16 v[16:31], v[184:187], v[64:67], v[16:31]
    s_waitcnt vmcnt(6)
    s_barrier
    ds_read_b128 v[64:67], v6 offset:0
    s_waitcnt lgkmcnt(5)
    v_mfma_f32_32x32x16_bf16 v[16:31], v[188:191], v[68:71], v[16:31]
    ds_read_b128 v[68:71], v6 offset:1024
    ds_read_b64_tr_b16 v[96:97], v9 offset:49152
    ds_read_b64_tr_b16 v[98:99], v9 offset:50176
    s_mov_b32 s3, 32768
    s_add_u32 m0, s73, 0
    s_nop 0
    buffer_load_dwordx4 v3, s[52:55], s3 offen sc1 lds
    s_waitcnt lgkmcnt(7)
    v_mfma_f32_32x32x16_bf16 v[16:31], v[192:195], v[48:51], v[16:31]
    ds_read_b128 v[48:51], v6 offset:2048
    ds_read_b64_tr_b16 v[100:101], v9 offset:51200
    ds_read_b64_tr_b16 v[102:103], v9 offset:52224
    s_add_u32 m0, s73, 0
    s_nop 0
    buffer_load_dwordx4 v3, s[52:55], s3 offen offset:1024 sc1 lds
    s_waitcnt lgkmcnt(9)
    v_mfma_f32_32x32x16_bf16 v[16:31], v[196:199], v[52:55], v[16:31]
    ds_read_b128 v[52:55], v6 offset:3072
    s_mul_i32 s4, s85, 14
    s_add_u32 s4, s4, 28672
    s_add_u32 m0, s72, 32768
    s_nop 0
    buffer_load_dwordx4 v8, s[40:43], s4 offen lds
    s_waitcnt lgkmcnt(9)
    v_mfma_f32_32x32x16_bf16 v[16:31], v[200:203], v[56:59], v[16:31]
    ds_read_b128 v[56:59], v6 offset:4096
    s_add_u32 m0, s72, 32768
    s_nop 0
    buffer_load_dwordx4 v4, s[40:43], s4 offen offset:1024 lds
    s_waitcnt lgkmcnt(9)
    v_mfma_f32_32x32x16_bf16 v[16:31], v[204:207], v[60:63], v[16:31]
    ds_read_b128 v[60:63], v6 offset:5120
    s_mul_i32 s4, s87, 14
    s_add_u32 s4, s4, 28672
    s_add_u32 m0, s72, 81920
    s_nop 0
    buffer_load_dwordx4 v8, s[40:43], s4 offen lds
    s_waitcnt lgkmcnt(9)
    v_mfma_f32_32x32x16_bf16 v[16:31], v[208:211], v[64:67], v[16:31]
    ds_read_b128 v[64:67], v6 offset:6144
    s_add_u32 m0, s72, 81920
    s_nop 0
    buffer_load_dwordx4 v4, s[40:43], s4 offen offset:1024 lds
    s_waitcnt lgkmcnt(9)
    v_mfma_f32_32x32x16_bf16 v[16:31], v[212:215], v[68:71], v[16:31]
    ds_read_b128 v[68:71], v6 offset:7168
    s_waitcnt vmcnt(8)
    v_cndmask_b32 v140, v140, 0, s[20:21]
    v_cndmask_b32 v141, v141, 0, s[20:21]
    v_cndmask_b32 v142, v142, 0, s[20:21]
    v_cndmask_b32 v143, v143, 0, s[20:21]
    v_pk_add_f32 v[128:129], v[128:129], v[132:133]
    v_pk_add_f32 v[136:137], v[136:137], v[140:141]
    v_pk_add_f32 v[130:131], v[130:131], v[134:135]
    v_pk_add_f32 v[138:139], v[138:139], v[142:143]
    v_pk_add_f32 v[128:129], v[128:129], v[136:137]
    v_pk_add_f32 v[130:131], v[130:131], v[138:139]
    v_lshlrev_b32 v14, 4, v0
    v_add_u32 v14, 147456, v14
    ds_write_b128 v14, v[128:131]
    s_waitcnt lgkmcnt(8)
    v_mfma_f32_32x32x16_bf16 v[16:31], v[216:219], v[48:51], v[16:31]
    s_waitcnt vmcnt(6)
    s_waitcnt lgkmcnt(0)
    s_barrier
    ds_read_b128 v[48:51], v6 offset:16384
    ds_read2st64_b32 v[128:129], v12 offset0:0 offset1:1
    ds_read2st64_b32 v[130:131], v12 offset0:2 offset1:3
    ds_read2st64_b32 v[132:133], v12 offset0:16 offset1:17
    ds_read2st64_b32 v[134:135], v12 offset0:18 offset1:19
    ds_read2st64_b32 v[136:137], v12 offset0:4 offset1:5
    ds_read2st64_b32 v[138:139], v12 offset0:6 offset1:7
    ds_read2st64_b32 v[140:141], v12 offset0:20 offset1:21
    ds_read2st64_b32 v[142:143], v12 offset0:22 offset1:23
    s_waitcnt lgkmcnt(14)
    v_mfma_f32_32x32x16_bf16 v[16:31], v[220:223], v[52:55], v[16:31]
    ds_read_b128 v[52:55], v6 offset:17408
    ds_read_b64_tr_b16 v[104:105], v10 offset:0
    ds_read_b64_tr_b16 v[106:107], v10 offset:1024
    s_mov_b32 s3, 40960
    s_add_u32 m0, s73, 16384
    s_nop 0
    buffer_load_dwordx4 v3, s[52:55], s3 offen sc1 lds
    s_waitcnt lgkmcnt(15)
    v_mfma_f32_32x32x16_bf16 v[16:31], v[224:227], v[56:59], v[16:31]
    ds_read_b128 v[56:59], v6 offset:18432
    ds_read_b64_tr_b16 v[108:109], v10 offset:2048
    ds_read_b64_tr_b16 v[110:111], v10 offset:3072
    s_add_u32 m0, s73, 16384
    s_nop 0
    buffer_load_dwordx4 v3, s[52:55], s3 offen offset:1024 sc1 lds
    s_waitcnt lgkmcnt(15)
    v_mfma_f32_32x32x16_bf16 v[16:31], v[228:231], v[60:63], v[16:31]
    ds_read_b128 v[60:63], v6 offset:19456
    s_mul_i32 s4, s86, 14
    s_add_u32 m0, s72, 49152
    s_nop 0
    buffer_load_dwordx4 v8, s[40:43], s4 offen lds
    s_waitcnt lgkmcnt(15)
    v_mfma_f32_32x32x16_bf16 v[16:31], v[232:235], v[64:67], v[16:31]
    ds_read_b128 v[64:67], v6 offset:20480
    s_add_u32 m0, s72, 49152
    s_nop 0
    buffer_load_dwordx4 v4, s[40:43], s4 offen offset:1024 lds
    s_waitcnt lgkmcnt(15)
    v_mfma_f32_32x32x16_bf16 v[16:31], v[236:239], v[68:71], v[16:31]
    ds_read_b128 v[68:71], v6 offset:21504
    s_mul_i32 s4, s88, 14
    s_add_u32 m0, s72, 98304
    s_nop 0
    buffer_load_dwordx4 v8, s[40:43], s4 offen lds
    s_waitcnt lgkmcnt(9)
    v_pk_add_f32 v[128:129], v[128:129], v[130:131]
    v_pk_add_f32 v[132:133], v[132:133], v[134:135]
    v_pk_add_f32 v[136:137], v[136:137], v[138:139]
    v_pk_add_f32 v[140:141], v[140:141], v[142:143]
    v_pk_add_f32 v[128:129], v[128:129], v[132:133]
    v_pk_add_f32 v[136:137], v[136:137], v[140:141]
    v_add_f32 v128, v128, v129
    v_add_f32 v136, v136, v137
    v_mul_f32 v128, 0xbb124925, v128
    v_mul_f32 v136, 0xbb124925, v136
    s_waitcnt lgkmcnt(15)
    v_mfma_f32_32x32x16_bf16 v[16:31], v[240:243], v[48:51], v[16:31]
    ds_read_b128 v[48:51], v6 offset:22528
    s_add_u32 m0, s72, 98304
    s_nop 0
    buffer_load_dwordx4 v4, s[40:43], s4 offen offset:1024 lds
    s_waitcnt lgkmcnt(9)
    v_mfma_f32_32x32x16_bf16 v[16:31], v[244:247], v[52:55], v[16:31]
    ds_read_b128 v[52:55], v6 offset:23552
    v_cvt_pk_bf16_f32 v72, v128, v128
    v_and_b32 v129, 0xffff0000, v72
    v_sub_f32 v129, v128, v129
    v_cvt_pk_bf16_f32 v73, v129, 0
    v_mov_b32 v74, 0
    v_mov_b32 v75, 0
    v_cvt_pk_bf16_f32 v140, v136, v136
    v_and_b32 v137, 0xffff0000, v140
    v_sub_f32 v137, v136, v137
    v_cvt_pk_bf16_f32 v141, v137, 0
    v_mov_b32 v142, 0
    v_mov_b32 v143, 0
    ds_read2st64_b32 v[128:129], v13 offset0:0 offset1:1
    ds_read2st64_b32 v[130:131], v13 offset0:2 offset1:3
    ds_read2st64_b32 v[132:133], v13 offset0:16 offset1:17
    ds_read2st64_b32 v[134:135], v13 offset0:18 offset1:19
    s_waitcnt lgkmcnt(11)
    v_mfma_f32_32x32x16_bf16 v[16:31], v[248:251], v[56:59], v[16:31]
    s_waitcnt vmcnt(8)
    s_barrier
    ds_read_b128 v[56:59], v5 offset:0
    s_waitcnt lgkmcnt(9)
    v_mfma_f32_32x32x16_bf16 v[16:31], v[252:255], v[60:63], v[16:31]
    ds_read_b128 v[60:63], v5 offset:1024
    ds_read_b64_tr_b16 v[112:113], v9 offset:32768
    ds_read_b64_tr_b16 v[114:115], v9 offset:33792
    s_mov_b32 s3, 49152
    s_add_u32 m0, s73, 114688
    s_nop 0
    buffer_load_dwordx4 v3, s[52:55], s3 offen sc1 lds
    v_mfma_f32_32x32x16_bf16 v[16:31], v[76:79], v[72:75], v[16:31]
    s_waitcnt lgkmcnt(11)
    v_mfma_f32_32x32x16_bf16 v[32:47], v[144:147], v[64:67], 0
    ds_read_b128 v[64:67], v5 offset:2048
    ds_read_b64_tr_b16 v[116:117], v9 offset:34816
    ds_read_b64_tr_b16 v[118:119], v9 offset:35840
    s_add_u32 m0, s73, 114688
    s_nop 0
    buffer_load_dwordx4 v3, s[52:55], s3 offen offset:1024 sc1 lds
    s_waitcnt lgkmcnt(13)
    v_mfma_f32_32x32x16_bf16 v[32:47], v[148:151], v[68:71], v[32:47]
    ds_read_b128 v[68:71], v5 offset:3072
    s_mul_i32 s4, s86, 14
    s_add_u32 s4, s4, 28672
    s_add_u32 m0, s72, 65536
    s_nop 0
    buffer_load_dwordx4 v8, s[40:43], s4 offen lds
    s_waitcnt lgkmcnt(13)
    v_mfma_f32_32x32x16_bf16 v[32:47], v[152:155], v[48:51], v[32:47]
    ds_read_b128 v[48:51], v5 offset:4096
    s_add_u32 m0, s72, 65536
    s_nop 0
    buffer_load_dwordx4 v4, s[40:43], s4 offen offset:1024 lds
    s_waitcnt lgkmcnt(13)
    v_mfma_f32_32x32x16_bf16 v[32:47], v[156:159], v[52:55], v[32:47]
    ds_read_b128 v[52:55], v5 offset:5120
    v_cvt_pk_bf16_f32 v16, v16, v17
    v_cvt_pk_bf16_f32 v17, v18, v19
    v_cvt_pk_bf16_f32 v18, v20, v21
    v_cvt_pk_bf16_f32 v19, v22, v23
    v_pk_max_i16 v16, v16, 0
    v_pk_max_i16 v17, v17, 0
    v_pk_max_i16 v18, v18, 0
    v_pk_max_i16 v19, v19, 0
    buffer_store_dwordx4 v[16:19], v7, s[52:55], 0 offen offset:0 sc1
    s_waitcnt lgkmcnt(9)
    v_mfma_f32_32x32x16_bf16 v[32:47], v[160:163], v[56:59], v[32:47]
    ds_read_b128 v[56:59], v5 offset:6144
    v_cvt_pk_bf16_f32 v24, v24, v25
    v_cvt_pk_bf16_f32 v25, v26, v27
    v_cvt_pk_bf16_f32 v26, v28, v29
    v_cvt_pk_bf16_f32 v27, v30, v31
    v_pk_max_i16 v24, v24, 0
    v_pk_max_i16 v25, v25, 0
    v_pk_max_i16 v26, v26, 0
    v_pk_max_i16 v27, v27, 0
    buffer_store_dwordx4 v[24:27], v7, s[52:55], 0 offen offset:1024 sc1
    s_waitcnt lgkmcnt(9)
    v_mfma_f32_32x32x16_bf16 v[32:47], v[164:167], v[60:63], v[32:47]
    ds_read_b128 v[60:63], v5 offset:7168
    s_waitcnt lgkmcnt(12)
    v_pk_add_f32 v[128:129], v[128:129], v[130:131]
    v_pk_add_f32 v[132:133], v[132:133], v[134:135]
    v_pk_add_f32 v[128:129], v[128:129], v[132:133]
    v_add_f32 v128, v128, v129
    v_mov_b32 v129, v128
    s_nop 1
    v_permlane32_swap_b32 v128, v129
    v_mul_f32 v130, 0xbb124925, v128
    v_mul_f32 v129, 0x3b124925, v129
    v_fma_f32 v129, -v130, v130, v129
    v_max_f32 v129, 0, v129
    v_add_f32 v129, 0x3727c5ac, v129
    v_rsq_f32 v84, v129
    s_waitcnt lgkmcnt(7)
    v_mfma_f32_32x32x16_bf16 v[32:47], v[168:171], v[64:67], v[32:47]
    s_waitcnt vmcnt(8)
    s_barrier
    ds_read_b128 v[64:67], v5 offset:16384
    s_waitcnt lgkmcnt(5)
    v_mfma_f32_32x32x16_bf16 v[32:47], v[172:175], v[68:71], v[32:47]
    ds_read_b128 v[68:71], v5 offset:17408
    ds_read_b64_tr_b16 v[120:121], v9 offset:49152
    ds_read_b64_tr_b16 v[122:123], v9 offset:50176
    s_waitcnt lgkmcnt(7)
    v_mfma_f32_32x32x16_bf16 v[32:47], v[176:179], v[48:51], v[32:47]
    ds_read_b128 v[48:51], v5 offset:18432
    ds_read_b64_tr_b16 v[124:125], v9 offset:51200
    ds_read_b64_tr_b16 v[126:127], v9 offset:52224
    s_waitcnt lgkmcnt(9)
    v_mfma_f32_32x32x16_bf16 v[32:47], v[180:183], v[52:55], v[32:47]
    ds_read_b128 v[52:55], v5 offset:19456
    s_mul_i32 s4, s87, 14
    s_add_u32 m0, s72, 32768
    s_nop 0
    buffer_load_dwordx4 v8, s[40:43], s4 offen lds
    s_waitcnt lgkmcnt(9)
    v_mfma_f32_32x32x16_bf16 v[32:47], v[184:187], v[56:59], v[32:47]
    ds_read_b128 v[56:59], v5 offset:20480
    s_add_u32 m0, s72, 32768
    s_nop 0
    buffer_load_dwordx4 v4, s[40:43], s4 offen offset:1024 lds
    s_waitcnt lgkmcnt(9)
    v_mfma_f32_32x32x16_bf16 v[32:47], v[188:191], v[60:63], v[32:47]
    ds_read_b128 v[60:63], v5 offset:21504
    s_mul_i32 s4, s88, 14
    s_add_u32 s4, s4, 28672
    s_add_u32 m0, s72, 131072
    s_nop 0
    buffer_load_dwordx4 v8, s[40:43], s4 offen lds
    s_waitcnt lgkmcnt(9)
    v_mfma_f32_32x32x16_bf16 v[32:47], v[192:195], v[64:67], v[32:47]
    ds_read_b128 v[64:67], v5 offset:22528
    s_add_u32 m0, s72, 131072
    s_nop 0
    buffer_load_dwordx4 v4, s[40:43], s4 offen offset:1024 lds
    s_waitcnt lgkmcnt(9)
    v_mfma_f32_32x32x16_bf16 v[32:47], v[196:199], v[68:71], v[32:47]
    ds_read_b128 v[68:71], v5 offset:23552
    s_waitcnt lgkmcnt(7)
    v_mfma_f32_32x32x16_bf16 v[32:47], v[200:203], v[48:51], v[32:47]
    s_waitcnt vmcnt(6)
    s_barrier
    ds_read_b128 v[48:51], v6 offset:0
    s_waitcnt lgkmcnt(5)
    v_mfma_f32_32x32x16_bf16 v[32:47], v[204:207], v[52:55], v[32:47]
    ds_read_b128 v[52:55], v6 offset:1024
    ds_read_b64_tr_b16 v[128:129], v10 offset:0
    ds_read_b64_tr_b16 v[130:131], v10 offset:1024
    s_waitcnt lgkmcnt(7)
    v_mfma_f32_32x32x16_bf16 v[32:47], v[208:211], v[56:59], v[32:47]
    ds_read_b128 v[56:59], v6 offset:2048
    ds_read_b64_tr_b16 v[132:133], v10 offset:2048
    ds_read_b64_tr_b16 v[134:135], v10 offset:3072
    s_waitcnt lgkmcnt(9)
    v_mfma_f32_32x32x16_bf16 v[32:47], v[212:215], v[60:63], v[32:47]
    ds_read_b128 v[60:63], v6 offset:3072
    s_waitcnt vmcnt(4)
    v_mov_b32 v14, s0
    v_mov_b32 v15, s77
    s_mov_b64 exec, 1
    s_cmp_eq_u32 s62, 1
    s_cbranch_scc0 SL_75
    buffer_store_dwordx2 v[14:15], off, s[52:55], s75 offset:0
    s_branch SL_76
SL_75:
    buffer_store_dwordx2 v[14:15], off, s[52:55], s75 offset:0 sc1
SL_76:
    s_mov_b64 exec, -1
    s_waitcnt lgkmcnt(9)
    v_mfma_f32_32x32x16_bf16 v[32:47], v[216:219], v[64:67], v[32:47]
    ds_read_b128 v[64:67], v6 offset:4096
    s_waitcnt lgkmcnt(9)
    v_mfma_f32_32x32x16_bf16 v[32:47], v[220:223], v[68:71], v[32:47]
    ds_read_b128 v[68:71], v6 offset:5120
    s_mul_i32 s4, s89, 14
    s_add_u32 m0, s72, 0
    s_nop 0
    buffer_load_dwordx4 v8, s[40:43], s4 offen lds
    s_waitcnt lgkmcnt(9)
    v_mfma_f32_32x32x16_bf16 v[32:47], v[224:227], v[48:51], v[32:47]
    ds_read_b128 v[48:51], v6 offset:6144
    s_add_u32 m0, s72, 0
    s_nop 0
    buffer_load_dwordx4 v4, s[40:43], s4 offen offset:1024 lds
    s_waitcnt lgkmcnt(9)
    v_mfma_f32_32x32x16_bf16 v[32:47], v[228:231], v[52:55], v[32:47]
    ds_read_b128 v[52:55], v6 offset:7168
    s_mul_i32 s4, s89, 14
    s_add_u32 s4, s4, 28672
    s_add_u32 m0, s72, 49152
    s_nop 0
    buffer_load_dwordx4 v8, s[40:43], s4 offen lds
    s_waitcnt lgkmcnt(7)
    v_mfma_f32_32x32x16_bf16 v[32:47], v[232:235], v[56:59], v[32:47]
    s_add_u32 m0, s72, 49152
    s_nop 0
    buffer_load_dwordx4 v4, s[40:43], s4 offen offset:1024 lds
    s_waitcnt lgkmcnt(4)
    v_mfma_f32_32x32x16_bf16 v[32:47], v[236:239], v[60:63], v[32:47]
    s_waitcnt lgkmcnt(3)
    v_mfma_f32_32x32x16_bf16 v[32:47], v[240:243], v[64:67], v[32:47]
    s_waitcnt lgkmcnt(2)
    v_mfma_f32_32x32x16_bf16 v[32:47], v[244:247], v[68:71], v[32:47]
    s_waitcnt lgkmcnt(1)
    v_mfma_f32_32x32x16_bf16 v[32:47], v[248:251], v[48:51], v[32:47]
    s_waitcnt lgkmcnt(0)
    v_mfma_f32_32x32x16_bf16 v[32:47], v[252:255], v[52:55], v[32:47]
    v_mfma_f32_32x32x16_bf16 v[32:47], v[76:79], v[140:143], v[32:47]
    s_lshl_b32 s3, s71, 12
    v_add_u32 v5, s3, v2
    v_add_u32 v6, 65536, v5
    v_add_u32 v72, 131072, v5
    v_add_u32 v73, 131072, v9
    v_lshl_add_u32 v13, v1, 3, s76
    ds_read_b64_tr_b16 v[144:145], v10 offset:16384
    ds_read_b64_tr_b16 v[146:147], v10 offset:17408
    ds_read_b64_tr_b16 v[148:149], v10 offset:18432
    ds_read_b64_tr_b16 v[150:151], v10 offset:19456
    ds_read_b64_tr_b16 v[152:153], v10 offset:32768
    ds_read_b64_tr_b16 v[154:155], v10 offset:33792
    ds_read_b64_tr_b16 v[156:157], v10 offset:34816
    ds_read_b64_tr_b16 v[158:159], v10 offset:35840
    s_cmp_lg_u32 s58, 0
    s_cbranch_scc1 PA_77
    s_mov_b32 exec_lo, 0xffffffff
    s_mov_b32 exec_hi, 0xffffff
    s_mov_b32 s22, 200000
    s_nop 15
POLLHA_78:
    buffer_load_dwordx2 v[14:15], v13, s[52:55], 0 offen sc1
    s_waitcnt vmcnt(0)
    v_xor_b32 v12, s1, v15
    v_and_b32 v12, 0xfffffff, v12
    v_xor_b32 v14, s0, v14
    v_or_b32 v12, v12, v14
    v_cmp_ne_u32 vcc, 0, v12
    s_sub_u32 s22, s22, 1
    s_cbranch_scc1 PDONEHA_79
    s_nop 2
    s_cbranch_vccz PDONEHA_79
    s_mov_b64 exec, vcc
    s_branch POLLHA_78
PDONEHA_79:
    s_mov_b64 exec, -1
PA_77:
    s_waitcnt vmcnt(0)
    s_waitcnt lgkmcnt(0)
    s_barrier
    s_add_u32 s3, s78, s84
    s_add_u32 m0, s72, 65536
    s_nop 0
    buffer_load_dwordx4 v2, s[52:55], s3 offen sc1 lds
    buffer_load_dwordx4 v2, s[52:55], s3 offen offset:1024 sc1 lds
    s_add_u32 s3, s78, s85
    s_add_u32 m0, s72, 16384
    s_nop 0
    buffer_load_dwordx4 v2, s[52:55], s3 offen sc1 lds
    buffer_load_dwordx4 v2, s[52:55], s3 offen offset:1024 sc1 lds
    s_add_u32 s3, s78, s86
    s_add_u32 m0, s72, 114688
    s_nop 0
    buffer_load_dwordx4 v2, s[52:55], s3 offen sc1 lds
    buffer_load_dwordx4 v2, s[52:55], s3 offen offset:1024 sc1 lds
    s_add_u32 s3, s78, s87
    s_add_u32 m0, s72, 147456
    s_nop 0
    buffer_load_dwordx4 v2, s[52:55], s3 offen sc1 lds
    buffer_load_dwordx4 v2, s[52:55], s3 offen offset:1024 sc1 lds
    v_cvt_pk_bf16_f32 v32, v32, v33
    v_cvt_pk_bf16_f32 v33, v34, v35
    v_cvt_pk_bf16_f32 v34, v36, v37
    v_cvt_pk_bf16_f32 v35, v38, v39
    v_pk_max_i16 v32, v32, 0
    v_pk_max_i16 v33, v33, 0
    v_pk_max_i16 v34, v34, 0
    v_pk_max_i16 v35, v35, 0
    buffer_store_dwordx4 v[32:35], v11, s[52:55], 0 offen offset:0 sc1
    v_cvt_pk_bf16_f32 v40, v40, v41
    v_cvt_pk_bf16_f32 v41, v42, v43
    v_cvt_pk_bf16_f32 v42, v44, v45
    v_cvt_pk_bf16_f32 v43, v46, v47
    v_pk_max_i16 v40, v40, 0
    v_pk_max_i16 v41, v41, 0
    v_pk_max_i16 v42, v42, 0
    v_pk_max_i16 v43, v43, 0
    buffer_store_dwordx4 v[40:43], v11, s[52:55], 0 offen offset:1024 sc1
    ds_read_b64_tr_b16 v[136:137], v9 offset:32768
    ds_read_b64_tr_b16 v[138:139], v9 offset:33792
    ds_read_b64_tr_b16 v[140:141], v9 offset:34816
    ds_read_b64_tr_b16 v[142:143], v9 offset:35840
    ds_read_b64_tr_b16 v[160:161], v73 offset:0
    ds_read_b64_tr_b16 v[162:163], v73 offset:1024
    ds_read_b64_tr_b16 v[164:165], v73 offset:2048
    ds_read_b64_tr_b16 v[166:167], v73 offset:3072
    ds_read_b64_tr_b16 v[168:169], v9 offset:0
    ds_read_b64_tr_b16 v[170:171], v9 offset:1024
    ds_read_b64_tr_b16 v[172:173], v9 offset:2048
    ds_read_b64_tr_b16 v[174:175], v9 offset:3072
    ds_read_b64_tr_b16 v[176:177], v9 offset:49152
    ds_read_b64_tr_b16 v[178:179], v9 offset:50176
    ds_read_b64_tr_b16 v[180:181], v9 offset:51200
    ds_read_b64_tr_b16 v[182:183], v9 offset:52224
    s_mul_i32 s4, s64, 32768
    s_add_u32 s4, s4, 98304
    s_lshl_b32 s3, s71, 11
    s_add_u32 s3, s3, s4
    v_add_u32 v74, s3, v2
    s_lshl_b32 s3, s60, 13
    s_add_u32 s3, s3, s4
    v_add_u32 v75, s3, v2
    v_add_u32 v13, 1024, v13
    s_waitcnt lgkmcnt(0)
    s_waitcnt vmcnt(8)
    s_barrier
    ds_read_b128 v[48:51], v6 offset:0
    ds_read_b128 v[52:55], v6 offset:1024
    ds_read_b128 v[56:59], v6 offset:2048
    ds_read_b128 v[60:63], v6 offset:3072
    s_waitcnt vmcnt(6)
    s_barrier
    ds_read_b128 v[64:67], v5 offset:16384
    ds_read_b128 v[68:71], v5 offset:17408
    s_waitcnt lgkmcnt(5)
    v_mfma_f32_32x32x16_bf16 v[16:31], v[88:91], v[48:51], 0
    ds_read_b128 v[48:51], v5 offset:18432
    s_add_u32 s3, s78, s88
    s_add_u32 m0, s72, 81920
    s_nop 0
    buffer_load_dwordx4 v2, s[52:55], s3 offen sc1 lds
    s_waitcnt lgkmcnt(5)
    v_mfma_f32_32x32x16_bf16 v[16:31], v[92:95], v[52:55], v[16:31]
    ds_read_b128 v[52:55], v5 offset:19456
    s_add_u32 m0, s72, 81920
    s_nop 0
    buffer_load_dwordx4 v2, s[52:55], s3 offen offset:1024 sc1 lds
    s_waitcnt lgkmcnt(5)
    v_mfma_f32_32x32x16_bf16 v[16:31], v[96:99], v[56:59], v[16:31]
    s_waitcnt vmcnt(6)
    s_barrier
    ds_read_b128 v[56:59], v6 offset:49152
    s_add_u32 s3, s78, s89
    s_add_u32 m0, s72, 98304
    s_nop 0
    buffer_load_dwordx4 v2, s[52:55], s3 offen sc1 lds
    s_waitcnt lgkmcnt(5)
    v_mfma_f32_32x32x16_bf16 v[16:31], v[100:103], v[60:63], v[16:31]
    ds_read_b128 v[60:63], v6 offset:50176
    s_add_u32 m0, s72, 98304
    s_nop 0
    buffer_load_dwordx4 v2, s[52:55], s3 offen offset:1024 sc1 lds
    s_waitcnt lgkmcnt(5)
    v_mfma_f32_32x32x16_bf16 v[16:31], v[104:107], v[64:67], v[16:31]
    ds_read_b128 v[64:67], v6 offset:51200
    s_add_u32 s3, s78, s90
    s_add_u32 m0, s72, 32768
    s_nop 0
    buffer_load_dwordx4 v2, s[52:55], s3 offen sc1 lds
    s_waitcnt lgkmcnt(5)
    v_mfma_f32_32x32x16_bf16 v[16:31], v[108:111], v[68:71], v[16:31]
    ds_read_b128 v[68:71], v6 offset:52224
    s_add_u32 m0, s72, 32768
    s_nop 0
    buffer_load_dwordx4 v2, s[52:55], s3 offen offset:1024 sc1 lds
    s_waitcnt lgkmcnt(5)
    v_mfma_f32_32x32x16_bf16 v[16:31], v[112:115], v[48:51], v[16:31]
    s_waitcnt vmcnt(8)
    s_barrier
    ds_read_b128 v[48:51], v72 offset:16384
    s_mul_i32 s4, s90, 14
    s_add_u32 m0, s72, 0
    s_nop 0
    buffer_load_dwordx4 v8, s[40:43], s4 offen lds
    s_waitcnt lgkmcnt(5)
    v_mfma_f32_32x32x16_bf16 v[16:31], v[116:119], v[52:55], v[16:31]
    ds_read_b128 v[52:55], v72 offset:17408
    s_add_u32 m0, s72, 0
    s_nop 0
    buffer_load_dwordx4 v4, s[40:43], s4 offen offset:1024 lds
    s_waitcnt lgkmcnt(5)
    v_mfma_f32_32x32x16_bf16 v[16:31], v[120:123], v[56:59], v[16:31]
    ds_read_b128 v[56:59], v72 offset:18432
    s_mul_i32 s4, s90, 14
    s_add_u32 s4, s4, 28672
    s_add_u32 m0, s72, 49152
    s_nop 0
    buffer_load_dwordx4 v8, s[40:43], s4 offen lds
    s_waitcnt vmcnt(9)
    v_mov_b32 v14, s0
    v_mov_b32 v15, s77
    s_mov_b64 exec, 1
    s_cmp_eq_u32 s62, 1
    s_cbranch_scc0 SL_80
    buffer_store_dwordx2 v[14:15], off, s[52:55], s75 offset:1024
    s_branch SL_81
SL_80:
    buffer_store_dwordx2 v[14:15], off, s[52:55], s75 offset:1024 sc1
SL_81:
    s_mov_b64 exec, -1
    s_waitcnt lgkmcnt(5)
    v_mfma_f32_32x32x16_bf16 v[16:31], v[124:127], v[60:63], v[16:31]
    ds_read_b128 v[60:63], v72 offset:19456
    s_add_u32 m0, s72, 49152
    s_nop 0
    buffer_load_dwordx4 v4, s[40:43], s4 offen offset:1024 lds
    s_waitcnt lgkmcnt(5)
    v_mfma_f32_32x32x16_bf16 v[16:31], v[128:131], v[64:67], v[16:31]
    s_waitcnt vmcnt(9)
    s_barrier
    ds_read_b128 v[64:67], v6 offset:16384
    s_cmp_eq_u32 s58, 0
    s_cselect_b32 exec_lo, -1, 1
    s_cselect_b32 exec_hi, 0xffffff, 0
    buffer_load_dwordx2 v[78:79], v13, s[52:55], 0 offen sc1
    s_mov_b64 exec, -1
    s_waitcnt lgkmcnt(5)
    v_mfma_f32_32x32x16_bf16 v[16:31], v[132:135], v[68:71], v[16:31]
    ds_read_b128 v[68:71], v6 offset:17408
    s_waitcnt lgkmcnt(5)
    v_mfma_f32_32x32x16_bf16 v[16:31], v[136:139], v[48:51], v[16:31]
    ds_read_b128 v[48:51], v6 offset:18432
    s_waitcnt lgkmcnt(5)
    v_mfma_f32_32x32x16_bf16 v[16:31], v[140:143], v[52:55], v[16:31]
    ds_read_b128 v[52:55], v6 offset:19456
    s_waitcnt lgkmcnt(5)
    v_mfma_f32_32x32x16_bf16 v[16:31], v[144:147], v[56:59], v[16:31]
    s_waitcnt vmcnt(1)
    s_cmp_lg_u32 s58, 0
    s_cbranch_scc1 PB_82
    s_waitcnt vmcnt(0)
    s_mov_b32 exec_lo, 0xffffffff
    s_mov_b32 exec_hi, 0xffffff
    v_xor_b32 v12, s1, v79
    v_and_b32 v12, 0xfffffff, v12
    v_xor_b32 v78, s0, v78
    v_or_b32 v12, v12, v78
    v_cmp_ne_u32 vcc, 0, v12
    s_mov_b64 exec, -1
    s_nop 3
    s_cbranch_vccz PB_82
    s_mov_b32 exec_lo, 0xffffffff
    s_mov_b32 exec_hi, 0xffffff
    s_mov_b32 s22, 200000
    s_nop 15
POLLHB_83:
    buffer_load_dwordx2 v[14:15], v13, s[52:55], 0 offen sc1
    s_waitcnt vmcnt(0)
    v_xor_b32 v12, s1, v15
    v_and_b32 v12, 0xfffffff, v12
    v_xor_b32 v14, s0, v14
    v_or_b32 v12, v12, v14
    v_cmp_ne_u32 vcc, 0, v12
    s_sub_u32 s22, s22, 1
    s_cbranch_scc1 PDONEHB_84
    s_nop 2
    s_cbranch_vccz PDONEHB_84
    s_mov_b64 exec, vcc
    s_branch POLLHB_83
PDONEHB_84:
    s_mov_b64 exec, -1
PB_82:
    s_barrier
    ds_read_b128 v[56:59], v6 offset:32768
    s_add_u32 s3, s78, s84
    s_add_u32 s3, s3, 114688
    s_add_u32 m0, s72, 131072
    s_nop 0
    buffer_load_dwordx4 v2, s[52:55], s3 offen sc1 lds
    s_waitcnt lgkmcnt(5)
    v_mfma_f32_32x32x16_bf16 v[16:31], v[148:151], v[60:63], v[16:31]
    ds_read_b128 v[60:63], v6 offset:33792
    s_add_u32 m0, s72, 131072
    s_nop 0
    buffer_load_dwordx4 v2, s[52:55], s3 offen offset:1024 sc1 lds
    ds_read_b64_tr_b16 v[184:185], v9 offset:0
    ds_read_b64_tr_b16 v[186:187], v9 offset:1024
    ds_read_b64_tr_b16 v[188:189], v9 offset:2048
    ds_read_b64_tr_b16 v[190:191], v9 offset:3072
    s_waitcnt lgkmcnt(9)
    v_mfma_f32_32x32x16_bf16 v[16:31], v[152:155], v[64:67], v[16:31]
    ds_read_b128 v[64:67], v6 offset:34816
    s_add_u32 s3, s78, s85
    s_add_u32 s3, s3, 114688
    s_add_u32 m0, s72, 65536
    s_nop 0
    buffer_load_dwordx4 v2, s[52:55], s3 offen sc1 lds
    ds_read_b64_tr_b16 v[192:193], v9 offset:49152
    ds_read_b64_tr_b16 v[194:195], v9 offset:50176
    ds_read_b64_tr_b16 v[196:197], v9 offset:51200
    ds_read_b64_tr_b16 v[198:199], v9 offset:52224
    s_waitcnt lgkmcnt(13)
    v_mfma_f32_32x32x16_bf16 v[16:31], v[156:159], v[68:71], v[16:31]
    ds_read_b128 v[68:71], v6 offset:35840
    s_add_u32 m0, s72, 65536
    s_nop 0
    buffer_load_dwordx4 v2, s[52:55], s3 offen offset:1024 sc1 lds
    s_waitcnt lgkmcnt(13)
    v_mfma_f32_32x32x16_bf16 v[16:31], v[160:163], v[48:51], v[16:31]
    s_waitcnt vmcnt(10)
    s_barrier
    ds_read_b128 v[48:51], v5 offset:32768
    s_add_u32 s3, s78, s86
    s_add_u32 s3, s3, 114688
    s_add_u32 m0, s72, 16384
    s_nop 0
    buffer_load_dwordx4 v2, s[52:55], s3 offen sc1 lds
    s_waitcnt lgkmcnt(13)
    v_mfma_f32_32x32x16_bf16 v[16:31], v[164:167], v[52:55], v[16:31]
    ds_read_b128 v[52:55], v5 offset:33792
    s_add_u32 m0, s72, 16384
    s_nop 0
    buffer_load_dwordx4 v2, s[52:55], s3 offen offset:1024 sc1 lds
    s_waitcnt lgkmcnt(13)
    v_mfma_f32_32x32x16_bf16 v[16:31], v[168:171], v[56:59], v[16:31]
    ds_read_b128 v[56:59], v5 offset:34816
    s_add_u32 s3, s78, s87
    s_add_u32 s3, s3, 114688
    s_add_u32 m0, s72, 114688
    s_nop 0
    buffer_load_dwordx4 v2, s[52:55], s3 offen sc1 lds
    v_lshlrev_b32 v200, 16, v80
    v_and_b32 v201, 0xffff0000, v80
    v_lshlrev_b32 v202, 16, v81
    v_and_b32 v203, 0xffff0000, v81
    v_lshlrev_b32 v204, 16, v82
    v_and_b32 v205, 0xffff0000, v82
    v_lshlrev_b32 v206, 16, v83
    v_and_b32 v207, 0xffff0000, v83
    v_mov_b32 v76, v84
    v_mov_b32 v77, v84
    s_waitcnt lgkmcnt(13)
    v_mfma_f32_32x32x16_bf16 v[16:31], v[172:175], v[60:63], v[16:31]
    ds_read_b128 v[60:63], v5 offset:35840
    s_add_u32 m0, s72, 114688
    s_nop 0
    buffer_load_dwordx4 v2, s[52:55], s3 offen offset:1024 sc1 lds
    s_waitcnt lgkmcnt(9)
    v_mfma_f32_32x32x16_bf16 v[16:31], v[176:179], v[64:67], v[16:31]
    s_waitcnt vmcnt(6)
    s_barrier
    ds_read_b128 v[64:67], v72 offset:0
    s_add_u32 s3, s78, s88
    s_add_u32 s3, s3, 114688
    s_add_u32 m0, s72, 147456
    s_nop 0
    buffer_load_dwordx4 v2, s[52:55], s3 offen sc1 lds
    s_waitcnt lgkmcnt(5)
    v_mfma_f32_32x32x16_bf16 v[16:31], v[180:183], v[68:71], v[16:31]
    ds_read_b128 v[68:71], v72 offset:1024
    s_add_u32 m0, s72, 147456
    s_nop 0
    buffer_load_dwordx4 v2, s[52:55], s3 offen offset:1024 sc1 lds
    s_waitcnt lgkmcnt(5)
    v_mfma_f32_32x32x16_bf16 v[16:31], v[184:187], v[48:51], v[16:31]
    ds_read_b128 v[48:51], v72 offset:2048
    s_add_u32 s3, s78, s89
    s_add_u32 s3, s3, 114688
    s_add_u32 m0, s72, 81920
    s_nop 0
    buffer_load_dwordx4 v2, s[52:55], s3 offen sc1 lds
    s_waitcnt lgkmcnt(5)
    v_mfma_f32_32x32x16_bf16 v[16:31], v[188:191], v[52:55], v[16:31]
    ds_read_b128 v[52:55], v72 offset:3072
    s_add_u32 m0, s72, 81920
    s_nop 0
    buffer_load_dwordx4 v2, s[52:55], s3 offen offset:1024 sc1 lds
    s_waitcnt lgkmcnt(5)
    v_mfma_f32_32x32x16_bf16 v[16:31], v[192:195], v[56:59], v[16:31]
    s_waitcnt vmcnt(8)
    s_barrier
    ds_read_b128 v[56:59], v6 offset:0
    s_waitcnt lgkmcnt(5)
    v_mfma_f32_32x32x16_bf16 v[16:31], v[196:199], v[60:63], v[16:31]
    ds_read_b128 v[60:63], v6 offset:1024
    s_waitcnt lgkmcnt(5)
    v_mfma_f32_32x32x16_bf16 v[32:47], v[88:91], v[64:67], 0
    ds_read_b128 v[64:67], v6 offset:2048
    s_waitcnt lgkmcnt(5)
    v_mfma_f32_32x32x16_bf16 v[32:47], v[92:95], v[68:71], v[32:47]
    ds_read_b128 v[68:71], v6 offset:3072
    s_waitcnt lgkmcnt(5)
    v_mfma_f32_32x32x16_bf16 v[32:47], v[96:99], v[48:51], v[32:47]
    s_waitcnt vmcnt(6)
    s_barrier
    ds_read_b128 v[48:51], v5 offset:16384
    s_add_u32 s3, s78, s90
    s_add_u32 s3, s3, 114688
    s_add_u32 m0, s72, 32768
    s_nop 0
    buffer_load_dwordx4 v2, s[52:55], s3 offen sc1 lds
    s_waitcnt lgkmcnt(5)
    v_mfma_f32_32x32x16_bf16 v[32:47], v[100:103], v[52:55], v[32:47]
    ds_read_b128 v[52:55], v5 offset:17408
    s_add_u32 m0, s72, 32768
    s_nop 0
    buffer_load_dwordx4 v2, s[52:55], s3 offen offset:1024 sc1 lds
    s_waitcnt lgkmcnt(5)
    v_mfma_f32_32x32x16_bf16 v[32:47], v[104:107], v[56:59], v[32:47]
    ds_read_b128 v[56:59], v5 offset:18432
    s_waitcnt lgkmcnt(5)
    v_mfma_f32_32x32x16_bf16 v[32:47], v[108:111], v[60:63], v[32:47]
    ds_read_b128 v[60:63], v5 offset:19456
    s_waitcnt lgkmcnt(5)
    v_mfma_f32_32x32x16_bf16 v[32:47], v[112:115], v[64:67], v[32:47]
    s_waitcnt vmcnt(6)
    s_barrier
    ds_read_b128 v[64:67], v6 offset:49152
    s_waitcnt lgkmcnt(5)
    v_mfma_f32_32x32x16_bf16 v[32:47], v[116:119], v[68:71], v[32:47]
    ds_read_b128 v[68:71], v6 offset:50176
    ds_write_b128 v74, v[16:19] offset:0
    s_waitcnt lgkmcnt(6)
    v_mfma_f32_32x32x16_bf16 v[32:47], v[120:123], v[48:51], v[32:47]
    ds_read_b128 v[48:51], v6 offset:51200
    s_waitcnt lgkmcnt(6)
    v_mfma_f32_32x32x16_bf16 v[32:47], v[124:127], v[52:55], v[32:47]
    ds_read_b128 v[52:55], v6 offset:52224
    ds_write_b128 v74, v[20:23] offset:1024
    s_waitcnt lgkmcnt(7)
    v_mfma_f32_32x32x16_bf16 v[32:47], v[128:131], v[56:59], v[32:47]
    s_waitcnt vmcnt(4)
    s_barrier
    ds_read_b128 v[56:59], v72 offset:16384
    s_waitcnt lgkmcnt(7)
    v_mfma_f32_32x32x16_bf16 v[32:47], v[132:135], v[60:63], v[32:47]
    ds_read_b128 v[60:63], v72 offset:17408
    ds_write_b128 v74, v[24:27] offset:8192
    s_waitcnt lgkmcnt(8)
    v_mfma_f32_32x32x16_bf16 v[32:47], v[136:139], v[64:67], v[32:47]
    ds_read_b128 v[64:67], v72 offset:18432
    s_waitcnt lgkmcnt(8)
    v_mfma_f32_32x32x16_bf16 v[32:47], v[140:143], v[68:71], v[32:47]
    ds_read_b128 v[68:71], v72 offset:19456
    ds_write_b128 v74, v[28:31] offset:9216
    s_waitcnt lgkmcnt(8)
    v_mfma_f32_32x32x16_bf16 v[32:47], v[144:147], v[48:51], v[32:47]
    s_waitcnt vmcnt(2)
    s_barrier
    ds_read_b128 v[48:51], v6 offset:16384
    s_waitcnt lgkmcnt(8)
    v_mfma_f32_32x32x16_bf16 v[32:47], v[148:151], v[52:55], v[32:47]
    ds_read_b128 v[52:55], v6 offset:17408
    s_waitcnt lgkmcnt(7)
    v_mfma_f32_32x32x16_bf16 v[32:47], v[152:155], v[56:59], v[32:47]
    ds_read_b128 v[56:59], v6 offset:18432
    s_waitcnt lgkmcnt(7)
    v_mfma_f32_32x32x16_bf16 v[32:47], v[156:159], v[60:63], v[32:47]
    ds_read_b128 v[60:63], v6 offset:19456
    s_waitcnt lgkmcnt(6)
    v_mfma_f32_32x32x16_bf16 v[32:47], v[160:163], v[64:67], v[32:47]
    s_waitcnt vmcnt(0)
    s_waitcnt lgkmcnt(4)
    s_barrier
    ds_read_b128 v[64:67], v5 offset:32768
    s_waitcnt lgkmcnt(6)
    v_mfma_f32_32x32x16_bf16 v[32:47], v[164:167], v[68:71], v[32:47]
    ds_read_b128 v[68:71], v5 offset:33792
    s_cmp_lg_u32 s65, 0
    s_cbranch_scc1 FN_85
    ds_read_b128 v[208:211], v75 offset:0
    ds_read_b128 v[212:215], v75 offset:1024
    ds_read_b128 v[216:219], v75 offset:2048
    ds_read_b128 v[220:223], v75 offset:3072
    ds_read_b128 v[224:227], v75 offset:4096
    ds_read_b128 v[228:231], v75 offset:5120
    ds_read_b128 v[232:235], v75 offset:6144
    ds_read_b128 v[236:239], v75 offset:7168
    s_waitcnt lgkmcnt(4)
    v_pk_add_f32 v[208:209], v[208:209], v[216:217]
    v_pk_add_f32 v[210:211], v[210:211], v[218:219]
    v_pk_add_f32 v[212:213], v[212:213], v[220:221]
    v_pk_add_f32 v[214:215], v[214:215], v[222:223]
    s_waitcnt lgkmcnt(0)
    v_pk_add_f32 v[224:225], v[224:225], v[232:233]
    v_pk_add_f32 v[226:227], v[226:227], v[234:235]
    v_pk_add_f32 v[228:229], v[228:229], v[236:237]
    v_pk_add_f32 v[230:231], v[230:231], v[238:239]
    v_pk_add_f32 v[208:209], v[208:209], v[224:225]
    v_pk_add_f32 v[210:211], v[210:211], v[226:227]
    v_pk_add_f32 v[212:213], v[212:213], v[228:229]
    v_pk_add_f32 v[214:215], v[214:215], v[230:231]
    v_pk_fma_f32 v[200:201], v[208:209], v[76:77], v[200:201]
    v_pk_fma_f32 v[202:203], v[210:211], v[76:77], v[202:203]
    v_pk_fma_f32 v[204:205], v[212:213], v[76:77], v[204:205]
    v_pk_fma_f32 v[206:207], v[214:215], v[76:77], v[206:207]
    v_cvt_pk_bf16_f32 v208, v200, v201
    v_cvt_pk_bf16_f32 v209, v202, v203
    v_cvt_pk_bf16_f32 v210, v204, v205
    v_cvt_pk_bf16_f32 v211, v206, v207
    s_nop 0
    v_permlane32_swap_b32 v208, v210
    v_permlane32_swap_b32 v209, v211
    buffer_store_dwordx4 v[208:211], v85, s[44:47], 0 offen
FN_85:
    s_waitcnt lgkmcnt(5)
    v_mfma_f32_32x32x16_bf16 v[32:47], v[168:171], v[48:51], v[32:47]
    ds_read_b128 v[48:51], v5 offset:34816
    s_waitcnt lgkmcnt(5)
    v_mfma_f32_32x32x16_bf16 v[32:47], v[172:175], v[52:55], v[32:47]
    ds_read_b128 v[52:55], v5 offset:35840
    s_waitcnt lgkmcnt(5)
    v_mfma_f32_32x32x16_bf16 v[32:47], v[176:179], v[56:59], v[32:47]
    s_waitcnt lgkmcnt(4)
    v_mfma_f32_32x32x16_bf16 v[32:47], v[180:183], v[60:63], v[32:47]
    s_waitcnt lgkmcnt(3)
    v_mfma_f32_32x32x16_bf16 v[32:47], v[184:187], v[64:67], v[32:47]
    s_waitcnt lgkmcnt(2)
    v_mfma_f32_32x32x16_bf16 v[32:47], v[188:191], v[68:71], v[32:47]
    s_waitcnt lgkmcnt(1)
    v_mfma_f32_32x32x16_bf16 v[32:47], v[192:195], v[48:51], v[32:47]
    s_waitcnt lgkmcnt(0)
    v_mfma_f32_32x32x16_bf16 v[32:47], v[196:199], v[52:55], v[32:47]
    v_subrev_u32 v74, 98304, v74
    v_subrev_u32 v75, 98304, v75
    s_mul_i32 s3, s64, 16384
    v_add_u32 v74, s3, v74
    v_add_u32 v75, s3, v75
    s_nop 6
    ds_write_b128 v74, v[32:35] offset:0
    ds_write_b128 v74, v[36:39] offset:1024
    ds_write_b128 v74, v[40:43] offset:8192
    ds_write_b128 v74, v[44:47] offset:9216
    s_waitcnt lgkmcnt(0)
    s_barrier
    s_cmp_lg_u32 s65, 1
    s_cbranch_scc1 FN_86
    ds_read_b128 v[208:211], v75 offset:0
    ds_read_b128 v[212:215], v75 offset:1024
    ds_read_b128 v[216:219], v75 offset:2048
    ds_read_b128 v[220:223], v75 offset:3072
    ds_read_b128 v[224:227], v75 offset:4096
    ds_read_b128 v[228:231], v75 offset:5120
    ds_read_b128 v[232:235], v75 offset:6144
    ds_read_b128 v[236:239], v75 offset:7168
    s_waitcnt lgkmcnt(4)
    v_pk_add_f32 v[208:209], v[208:209], v[216:217]
    v_pk_add_f32 v[210:211], v[210:211], v[218:219]
    v_pk_add_f32 v[212:213], v[212:213], v[220:221]
    v_pk_add_f32 v[214:215], v[214:215], v[222:223]
    s_waitcnt lgkmcnt(0)
    v_pk_add_f32 v[224:225], v[224:225], v[232:233]
    v_pk_add_f32 v[226:227], v[226:227], v[234:235]
    v_pk_add_f32 v[228:229], v[228:229], v[236:237]
    v_pk_add_f32 v[230:231], v[230:231], v[238:239]
    v_pk_add_f32 v[208:209], v[208:209], v[224:225]
    v_pk_add_f32 v[210:211], v[210:211], v[226:227]
    v_pk_add_f32 v[212:213], v[212:213], v[228:229]
    v_pk_add_f32 v[214:215], v[214:215], v[230:231]
    v_pk_fma_f32 v[200:201], v[208:209], v[76:77], v[200:201]
    v_pk_fma_f32 v[202:203], v[210:211], v[76:77], v[202:203]
    v_pk_fma_f32 v[204:205], v[212:213], v[76:77], v[204:205]
    v_pk_fma_f32 v[206:207], v[214:215], v[76:77], v[206:207]
    v_cvt_pk_bf16_f32 v208, v200, v201
    v_cvt_pk_bf16_f32 v209, v202, v203
    v_cvt_pk_bf16_f32 v210, v204, v205
    v_cvt_pk_bf16_f32 v211, v206, v207
    s_nop 0
    v_permlane32_swap_b32 v208, v210
    v_permlane32_swap_b32 v209, v211
    buffer_store_dwordx4 v[208:211], v85, s[44:47], 0 offen
FN_86:
L_FIN:
L_END:
    s_endpgm
PADW_1:
    s_waitcnt lgkmcnt(0)
    s_mov_b32 s24, s72
    s_and_b32 s25, s73, 0xffff
    s_mov_b32 s26, 1835008
    s_mov_b32 s27, 0x20000
    s_mov_b32 s28, s74
    s_and_b32 s29, s75, 0xffff
    s_mov_b32 s30, 1204224
    s_mov_b32 s31, 0x20000
    s_mov_b32 s32, s76
    s_and_b32 s33, s77, 0xffff
    s_mov_b32 s34, 401408
    s_mov_b32 s35, 0x20000
    s_mov_b32 s36, s80
    s_and_b32 s37, s81, 0xffff
    s_mov_b32 s38, 1605632
    s_mov_b32 s39, 0x20000
    s_mov_b32 s40, s82
    s_and_b32 s41, s83, 0xffff
    s_mov_b32 s42, 1605632
    s_mov_b32 s43, 0x20000
    s_mov_b32 s44, s84
    s_and_b32 s45, s85, 0xffff
    s_mov_b32 s46, 1835008
    s_mov_b32 s47, 0x20000
    s_mov_b32 s48, s86
    s_and_b32 s49, s87, 0xffff
    s_mov_b32 s50, 256
    s_mov_b32 s51, 0x20000
    s_mov_b32 s52, s88
    s_and_b32 s53, s89, 0xffff
    s_mov_b32 s54, 41943040
    s_mov_b32 s55, 0x20000
    s_cmp_lg_u32 s2, 112
    s_cbranch_scc1 NOTOK_100001
    s_cmp_lg_u32 s58, 0
    s_cbranch_scc1 NOTOK_100001
    s_memrealtime s[98:99]
    s_waitcnt lgkmcnt(0)
    s_or_b32 s3, s98, 1
    s_and_b32 s4, s99, 0xfffffff
    v_mov_b32 v14, s3
    v_mov_b32 v15, s4
    s_mov_b64 exec, 1
    buffer_store_dwordx2 v[14:15], off, s[48:51], 0 sc1
    s_mov_b64 exec, -1
NOTOK_100001:
    s_lshl_b32 s3, s56, 7
    s_sub_u32 s4, s57, 14
    s_lshl_b32 s4, s4, 6
    s_add_u32 s3, s3, s4
    v_lshrrev_b32 v2, 3, v0
    v_add_u32 v2, s3, v2
    v_mul_u32_u24 v3, 896, v2
    v_and_b32 v14, 7, v0
    v_lshl_add_u32 v3, v14, 4, v3
    buffer_load_dwordx4 v[32:35], v3, s[24:27], 0 offen offset:0
    buffer_load_dwordx4 v[36:39], v3, s[24:27], 0 offen offset:128
    buffer_load_dwordx4 v[40:43], v3, s[24:27], 0 offen offset:256
    buffer_load_dwordx4 v[44:47], v3, s[24:27], 0 offen offset:384
    buffer_load_dwordx4 v[48:51], v3, s[24:27], 0 offen offset:512
    buffer_load_dwordx4 v[52:55], v3, s[24:27], 0 offen offset:640
    buffer_load_dwordx4 v[56:59], v3, s[24:27], 0 offen offset:768
    s_lshl_b32 s3, s56, 9
    s_add_u32 s3, s3, 33570816
    v_lshl_add_u32 v14, v1, 7, s3
    s_lshl_b32 s3, s56, 7
    s_add_u32 s4, s3, 33587200
    v_writelane_b32 v14, s4, 4
    s_lshl_b32 s3, s56, 11
    s_add_u32 s3, s3, 33601536
    v_lshl_add_u32 v15, v1, 7, s3
    v_cmp_le_u32 vcc, 16, v1
    s_nop 1
    v_cndmask_b32 v14, v14, v15, vcc
    s_mov_b32 exec_lo, 0xffff001f
    s_mov_b32 exec_hi, 0x0
    buffer_load_dword v86, v14, s[52:55], 0 offen sc1
    s_mov_b64 exec, -1
    v_mov_b32 v4, 0
    v_mov_b32 v5, 0
    s_waitcnt vmcnt(7)
    v_dot2c_f32_bf16 v4, s96, v32
    v_dot2c_f32_bf16 v4, s96, v33
    v_dot2c_f32_bf16 v4, s96, v34
    v_dot2c_f32_bf16 v4, s96, v35
    v_dot2c_f32_bf16 v5, v32, v32
    v_dot2c_f32_bf16 v5, v33, v33
    v_dot2c_f32_bf16 v5, v34, v34
    v_dot2c_f32_bf16 v5, v35, v35
    s_waitcnt vmcnt(6)
    v_dot2c_f32_bf16 v4, s96, v36
    v_dot2c_f32_bf16 v4, s96, v37
    v_dot2c_f32_bf16 v4, s96, v38
    v_dot2c_f32_bf16 v4, s96, v39
    v_dot2c_f32_bf16 v5, v36, v36
    v_dot2c_f32_bf16 v5, v37, v37
    v_dot2c_f32_bf16 v5, v38, v38
    v_dot2c_f32_bf16 v5, v39, v39
    s_waitcnt vmcnt(5)
    v_dot2c_f32_bf16 v4, s96, v40
    v_dot2c_f32_bf16 v4, s96, v41
    v_dot2c_f32_bf16 v4, s96, v42
    v_dot2c_f32_bf16 v4, s96, v43
    v_dot2c_f32_bf16 v5, v40, v40
    v_dot2c_f32_bf16 v5, v41, v41
    v_dot2c_f32_bf16 v5, v42, v42
    v_dot2c_f32_bf16 v5, v43, v43
    s_waitcnt vmcnt(4)
    buffer_load_dwordx2 v[24:25], off, s[48:51], 0 sc1
    v_dot2c_f32_bf16 v4, s96, v44
    v_dot2c_f32_bf16 v4, s96, v45
    v_dot2c_f32_bf16 v4, s96, v46
    v_dot2c_f32_bf16 v4, s96, v47
    v_dot2c_f32_bf16 v5, v44, v44
    v_dot2c_f32_bf16 v5, v45, v45
    v_dot2c_f32_bf16 v5, v46, v46
    v_dot2c_f32_bf16 v5, v47, v47
    s_waitcnt vmcnt(3)
    v_dot2c_f32_bf16 v4, s96, v48
    v_dot2c_f32_bf16 v4, s96, v49
    v_dot2c_f32_bf16 v4, s96, v50
    v_dot2c_f32_bf16 v4, s96, v51
    v_dot2c_f32_bf16 v5, v48, v48
    v_dot2c_f32_bf16 v5, v49, v49
    v_dot2c_f32_bf16 v5, v50, v50
    v_dot2c_f32_bf16 v5, v51, v51
    s_waitcnt vmcnt(2)
    v_dot2c_f32_bf16 v4, s96, v52
    v_dot2c_f32_bf16 v4, s96, v53
    v_dot2c_f32_bf16 v4, s96, v54
    v_dot2c_f32_bf16 v4, s96, v55
    v_dot2c_f32_bf16 v5, v52, v52
    v_dot2c_f32_bf16 v5, v53, v53
    v_dot2c_f32_bf16 v5, v54, v54
    v_dot2c_f32_bf16 v5, v55, v55
    s_waitcnt vmcnt(1)
    s_waitcnt vmcnt(0)
    v_dot2c_f32_bf16 v4, s96, v56
    v_dot2c_f32_bf16 v4, s96, v57
    v_dot2c_f32_bf16 v4, s96, v58
    v_dot2c_f32_bf16 v4, s96, v59
    v_dot2c_f32_bf16 v5, v56, v56
    v_dot2c_f32_bf16 v5, v57, v57
    v_dot2c_f32_bf16 v5, v58, v58
    v_dot2c_f32_bf16 v5, v59, v59
    v_add_f32_dpp v4, v4, v4 quad_perm:[1,0,3,2] row_mask:0xf bank_mask:0xf
    s_nop 1
    v_add_f32_dpp v5, v5, v5 quad_perm:[1,0,3,2] row_mask:0xf bank_mask:0xf
    v_add_f32_dpp v4, v4, v4 quad_perm:[2,3,0,1] row_mask:0xf bank_mask:0xf
    s_nop 0
    v_add_f32_dpp v5, v5, v5 quad_perm:[2,3,0,1] row_mask:0xf bank_mask:0xf
    v_add_f32_dpp v4, v4, v4 row_half_mirror row_mask:0xf bank_mask:0xf
    s_nop 0
    v_add_f32_dpp v5, v5, v5 row_half_mirror row_mask:0xf bank_mask:0xf
    v_mul_f32 v6, 0xbb124925, v4
    v_mul_f32 v5, 0x3b124925, v5
    v_fma_f32 v5, -v6, v6, v5
    v_max_f32 v5, 0, v5
    v_add_f32 v5, 0x3727c5ac, v5
    v_rsq_f32 v7, v5
    v_cvt_pk_bf16_f32 v20, v6, v6
    v_and_b32 v8, 0xffff0000, v20
    v_sub_f32 v8, v6, v8
    v_cvt_pk_bf16_f32 v21, v8, 0
    v_mov_b32 v22, 0
    v_mov_b32 v23, 0
    v_mov_b32 v22, v7
    s_mov_b32 s22, 200000
    s_nop 15
TOK_100002:
    v_readfirstlane_b32 s0, v24
    v_readfirstlane_b32 s1, v25
    s_nop 0
    s_cmp_lg_u32 s0, 0
    s_cbranch_scc1 TOKD_100003
    s_sub_u32 s22, s22, 1
    s_cbranch_scc1 TOKD_100003
    s_sleep 4
    buffer_load_dwordx2 v[24:25], off, s[48:51], 0 sc1
    s_waitcnt vmcnt(0)
    s_branch TOK_100002
TOKD_100003:
    s_lshl_b32 s3, s1, 16
    v_or_b32 v21, s3, v21
    v_mov_b32 v23, s0
    v_lshlrev_b32 v2, 4, v2
    v_add_u32 v2, 11534336, v2
    s_mov_b32 exec_lo, 0x1010101
    s_mov_b32 exec_hi, 0x1010101
    buffer_store_dwordx4 v[20:23], v2, s[52:55], 0 offen sc1
    s_mov_b64 exec, -1
    s_sub_u32 s3, s57, 14
    s_lshl_b32 s3, s3, 3
    s_add_u32 s3, s3, s58
    s_lshl_b32 s3, s3, 6
    s_lshl_b32 s4, s56, 2
    s_add_u32 s3, s3, s4
    s_lshl_b32 s3, s3, 11
    s_add_u32 s3, s3, 6291456
    v_lshlrev_b32 v14, 7, v1
    buffer_load_dword v86, v14, s[52:55], s3 offen sc1
    s_mul_i32 s3, s57, 7
    s_lshr_b32 s3, s3, 1
    v_lshrrev_b32 v14, 5, v1
    v_and_b32 v69, 31, v1
    v_add3_u32 v15, v14, s3, 0
    v_lshrrev_b32 v65, 2, v15
    v_lshlrev_b32 v65, 17, v65
    v_and_b32 v15, 3, v15
    v_lshl_add_u32 v65, v15, 9, v65
    v_add3_u32 v15, v14, s3, 2
    v_lshrrev_b32 v66, 2, v15
    v_lshlrev_b32 v66, 17, v66
    v_and_b32 v15, 3, v15
    v_lshl_add_u32 v66, v15, 9, v66
    s_and_b32 s82, s58, 1
    s_cmp_eq_u32 s82, 1
    s_cselect_b64 s[18:19], -1, 0
    v_cndmask_b32 v68, v65, v66, s[18:19]
    v_lshl_add_u32 v67, v69, 4, v68
    s_lshl_b32 s4, s82, 1
    v_add_u32 v15, s4, v14
    v_lshlrev_b32 v15, 2, v15
    v_sub_u32 v15, v69, v15
    v_and_b32 v15, 31, v15
    v_lshl_add_u32 v68, v15, 4, v68
    v_lshl_add_u32 v65, v69, 4, v65
    v_lshl_add_u32 v66, v69, 4, v66
    s_lshl_b32 s4, s56, 2
    s_add_u32 s5, s4, s59
    s_lshl_b32 s72, s5, 11
    s_lshl_b32 s6, s57, 17
    s_add_u32 s73, s72, s6
    s_add_u32 s73, s73, 6291456
    s_lshr_b32 s6, s58, 1
    s_mul_i32 s6, s6, 3
    s_add_u32 s4, s4, s6
    s_add_u32 s4, s4, 888
    s_lshl_b32 s74, s4, 11
    s_lshl_b32 s6, s6, 11
    s_lshl_b32 s75, s82, 10
    s_add_u32 s75, s75, s6
    s_lshl_b32 s3, s60, 2
    s_sub_u32 s76, s59, s3
    s_add_u32 s76, s76, 4
    s_lshl_b32 s3, s76, 11
    s_add_u32 s3, s3, 90112
    v_lshl_add_u32 v2, v1, 4, s3
    v_bfe_u32 v14, v1, 4, 1
    v_and_b32 v3, 3, v1
    v_lshl_add_u32 v14, v14, 2, v3
    v_lshrrev_b32 v15, 1, v14
    v_lshrrev_b32 v3, 5, v1
    v_add_u32 v3, v3, v15
    v_bfe_u32 v4, v1, 2, 2
    v_lshl_add_u32 v8, v3, 2, v4
    v_lshl_add_u32 v15, v15, 9, s3
    v_and_b32 v3, 1, v1
    v_lshl_add_u32 v15, v3, 3, v15
    v_add_u32 v15, 24576, v15
    s_and_b32 s4, s57, 1
    s_mul_i32 s4, s4, 7
    s_sub_u32 s4, 7, s4
    v_cmp_eq_u32 s[18:19], s4, v14
    v_mov_b32 v14, 140288
    v_add_u32 v3, 0, v8
    v_and_b32 v3, 31, v3
    v_lshl_add_u32 v3, v3, 4, v15
    v_cndmask_b32 v3, v3, v14, s[18:19]
    v_add_u32 v4, 8, v8
    v_and_b32 v4, 31, v4
    v_lshl_add_u32 v4, v4, 4, v15
    v_cndmask_b32 v4, v4, v14, s[18:19]
    v_add_u32 v5, 16, v8
    v_and_b32 v5, 31, v5
    v_lshl_add_u32 v5, v5, 4, v15
    v_cndmask_b32 v5, v5, v14, s[18:19]
    v_add_u32 v6, 24, v8
    v_and_b32 v6, 31, v6
    v_lshl_add_u32 v6, v6, 4, v15
    v_cndmask_b32 v6, v6, v14, s[18:19]
    s_lshl_b32 s3, s56, 2
    s_sub_i32 s77, 8, s3
    s_sub_i32 s77, s77, s76
    s_mov_b32 s3, 0
    s_lshl_b32 s5, s57, 8
    v_lshrrev_b32 v14, 3, v1
    v_bfe_u32 v15, v1, 4, 1
    v_lshlrev_b32 v15, 2, v15
    v_xor_b32 v15, v15, v1
    v_and_b32 v15, 7, v15
    v_add_u32 v14, s3, v14
    v_mul_u32_u24 v14, 3584, v14
    v_lshl_add_u32 v14, v15, 4, v14
    v_add_u32 v9, s5, v14
    s_mul_i32 s78, s58, 28672
    s_lshl_b32 s79, s58, 10
    s_mul_i32 s80, s59, 28672
    s_lshl_b32 s81, s59, 10
    s_mul_i32 s3, s59, 4608
    s_add_u32 s3, s3, 139264
    v_lshl_add_u32 v7, v1, 4, s3
    s_lshl_b32 s4, s60, 8
    s_add_u32 s3, s3, s4
    s_add_u32 s3, s3, 4096
    v_lshl_add_u32 v8, v1, 2, s3
    v_xor_b32 v11, 256, v8
    v_lshl_add_u32 v10, v1, 4, s73
    v_lshrrev_b32 v14, 4, v1
    v_sub_u32 v14, s56, v14
    v_max_i32 v14, 0, v14
    v_and_b32 v15, 15, v1
    v_cmp_le_u32 vcc, 7, v15
    s_nop 1
    v_cndmask_b32 v62, 0, 1, vcc
    v_and_b32 v60, 12, v14
    v_lshl_add_u32 v60, v62, 1, v60
    v_bfe_u32 v61, v14, 1, 1
    v_add_u32 v60, v60, v61
    v_and_b32 v61, 1, v14
    v_sub_u32 v61, v61, v62
    v_mad_i32_i24 v61, v61, 7, v15
    v_cmp_le_u32 vcc, 14, v15
    s_nop 1
    v_cndmask_b32 v60, v60, v14, vcc
    v_cndmask_b32 v61, v61, v15, vcc
    v_mov_b32 v62, s56
    v_cmp_le_u32 vcc, 48, v1
    s_nop 1
    v_cndmask_b32 v60, v60, v62, vcc
    v_cndmask_b32 v61, v61, v15, vcc
    v_lshl_add_u32 v60, v60, 4, v61
    v_lshlrev_b32 v14, 7, v60
    v_add_u32 v61, 33685504, v14
    s_mov_b32 s16, s72
    s_mov_b32 s101, s73
    s_mov_b32 s14, s74
    s_mov_b32 s15, s75
    s_mov_b32 s7, s76
    s_mov_b32 s8, s77
    s_mov_b32 s10, s78
    s_mov_b32 s11, s79
    v_mov_b32 v14, 140288
    v_lshl_add_u32 v14, v1, 11, v14
    v_mov_b32 v70, 0x3f80
    v_mov_b32 v71, 0
    s_mov_b64 exec, 31
    ds_write_b64 v14, v[70:71]
    s_mov_b64 exec, -1
    s_lshl_b32 s4, s56, 11
    s_lshl_b32 s5, s57, 7
    s_add_u32 s4, s4, s5
    s_add_u32 s4, s4, 33685504
    s_lshl_b32 s5, s61, 28
    s_or_b32 s5, s5, s1
    v_mov_b32 v13, s4
    v_mov_b32 v14, s0
    v_mov_b32 v15, s5
    s_waitcnt vmcnt(0) lgkmcnt(0)
    s_barrier
    s_cmp_lg_u32 s58, 0
    s_cbranch_scc1 PUB_100004
    s_mov_b64 exec, 1
    buffer_store_dwordx2 v[14:15], v13, s[52:55], 0 offen sc1
    s_mov_b64 exec, -1
PUB_100004:
    s_and_b32 s3, s56, 1
    s_lshl_b32 s3, s3, 1
    s_add_u32 s3, s3, s57
    s_sub_u32 s3, s3, 14
    s_lshl_b32 s4, s3, 2
    s_add_u32 s4, s4, s59
    s_lshl_b32 s4, s4, 13
    v_lshl_add_u32 v56, v1, 7, s4
    v_mov_b32 v58, 163328
    s_cmp_eq_u32 s60, 0
    s_cbranch_scc1 IR_100005
    s_mov_b32 s3, 0
    buffer_load_dword v86, v56, s[32:35], s3 offen
    s_waitcnt vmcnt(0)
IR_100005:
    s_cmp_lg_u32 s58, 0
    s_cbranch_scc1 IR_100006
    buffer_load_dwordx2 v[62:63], v61, s[52:55], 0 offen sc1
    s_waitcnt vmcnt(0)
    v_xor_b32 v64, s1, v63
    v_and_b32 v64, 0xfffffff, v64
    v_xor_b32 v62, s0, v62
    v_or_b32 v64, v64, v62
    v_cmp_ne_u32 vcc, 0, v64
    s_nop 1
    s_bcnt1_i32_b64 s3, vcc
    v_mov_b32 v59, s3
    ds_write_b32 v58, v59
IR_100006:
    s_waitcnt lgkmcnt(0)
    s_barrier
    ds_read_b32 v59, v58
    s_waitcnt lgkmcnt(0)
    v_readfirstlane_b32 s3, v59
    s_barrier
    s_nop 0
    s_cmp_lt_u32 s3, 50
    s_cbranch_scc1 L_P2POLL
    s_cmp_eq_u32 s60, 0
    s_cbranch_scc1 IR_100007
    s_mov_b32 s3, 131072
    buffer_load_dword v86, v56, s[32:35], s3 offen
    s_waitcnt vmcnt(0)
IR_100007:
    s_cmp_lg_u32 s58, 0
    s_cbranch_scc1 IR_100008
    buffer_load_dwordx2 v[62:63], v61, s[52:55], 0 offen sc1
    s_waitcnt vmcnt(0)
    v_xor_b32 v64, s1, v63
    v_and_b32 v64, 0xfffffff, v64
    v_xor_b32 v62, s0, v62
    v_or_b32 v64, v64, v62
    v_cmp_ne_u32 vcc, 0, v64
    s_nop 1
    s_bcnt1_i32_b64 s3, vcc
    v_mov_b32 v59, s3
    ds_write_b32 v58, v59
IR_100008:
    s_waitcnt lgkmcnt(0)
    s_barrier
    ds_read_b32 v59, v58
    s_waitcnt lgkmcnt(0)
    v_readfirstlane_b32 s3, v59
    s_barrier
    s_nop 0
    s_cmp_lt_u32 s3, 50
    s_cbranch_scc1 L_P2POLL
    s_cmp_eq_u32 s60, 0
    s_cbranch_scc1 IR_100009
    s_mov_b32 s3, 262144
    buffer_load_dword v86, v56, s[32:35], s3 offen
    s_waitcnt vmcnt(0)
IR_100009:
    s_cmp_lg_u32 s58, 0
    s_cbranch_scc1 IR_100010
    buffer_load_dwordx2 v[62:63], v61, s[52:55], 0 offen sc1
    s_waitcnt vmcnt(0)
    v_xor_b32 v64, s1, v63
    v_and_b32 v64, 0xfffffff, v64
    v_xor_b32 v62, s0, v62
    v_or_b32 v64, v64, v62
    v_cmp_ne_u32 vcc, 0, v64
    s_nop 1
    s_bcnt1_i32_b64 s3, vcc
    v_mov_b32 v59, s3
    ds_write_b32 v58, v59
IR_100010:
    s_waitcnt lgkmcnt(0)
    s_barrier
    ds_read_b32 v59, v58
    s_waitcnt lgkmcnt(0)
    v_readfirstlane_b32 s3, v59
    s_barrier
    s_nop 0
    s_cmp_lt_u32 s3, 50
    s_cbranch_scc1 L_P2POLL
    s_cmp_eq_u32 s60, 0
    s_cbranch_scc1 IR_100011
    s_mov_b32 s3, 0
    buffer_load_dword v86, v56, s[36:39], s3 offen
    s_waitcnt vmcnt(0)
IR_100011:
    s_cmp_lg_u32 s58, 0
    s_cbranch_scc1 IR_100012
    buffer_load_dwordx2 v[62:63], v61, s[52:55], 0 offen sc1
    s_waitcnt vmcnt(0)
    v_xor_b32 v64, s1, v63
    v_and_b32 v64, 0xfffffff, v64
    v_xor_b32 v62, s0, v62
    v_or_b32 v64, v64, v62
    v_cmp_ne_u32 vcc, 0, v64
    s_nop 1
    s_bcnt1_i32_b64 s3, vcc
    v_mov_b32 v59, s3
    ds_write_b32 v58, v59
IR_100012:
    s_waitcnt lgkmcnt(0)
    s_barrier
    ds_read_b32 v59, v58
    s_waitcnt lgkmcnt(0)
    v_readfirstlane_b32 s3, v59
    s_barrier
    s_nop 0
    s_cmp_lt_u32 s3, 50
    s_cbranch_scc1 L_P2POLL
    s_cmp_eq_u32 s60, 0
    s_cbranch_scc1 IR_100013
    s_mov_b32 s3, 131072
    buffer_load_dword v86, v56, s[36:39], s3 offen
    s_waitcnt vmcnt(0)
IR_100013:
    s_cmp_lg_u32 s58, 0
    s_cbranch_scc1 IR_100014
    buffer_load_dwordx2 v[62:63], v61, s[52:55], 0 offen sc1
    s_waitcnt vmcnt(0)
    v_xor_b32 v64, s1, v63
    v_and_b32 v64, 0xfffffff, v64
    v_xor_b32 v62, s0, v62
    v_or_b32 v64, v64, v62
    v_cmp_ne_u32 vcc, 0, v64
    s_nop 1
    s_bcnt1_i32_b64 s3, vcc
    v_mov_b32 v59, s3
    ds_write_b32 v58, v59
IR_100014:
    s_waitcnt lgkmcnt(0)
    s_barrier
    ds_read_b32 v59, v58
    s_waitcnt lgkmcnt(0)
    v_readfirstlane_b32 s3, v59
    s_barrier
    s_nop 0
    s_cmp_lt_u32 s3, 50
    s_cbranch_scc1 L_P2POLL
    s_cmp_eq_u32 s60, 0
    s_cbranch_scc1 IR_100015
    s_mov_b32 s3, 262144
    buffer_load_dword v86, v56, s[36:39], s3 offen
    s_waitcnt vmcnt(0)
IR_100015:
    s_cmp_lg_u32 s58, 0
    s_cbranch_scc1 IR_100016
    buffer_load_dwordx2 v[62:63], v61, s[52:55], 0 offen sc1
    s_waitcnt vmcnt(0)
    v_xor_b32 v64, s1, v63
    v_and_b32 v64, 0xfffffff, v64
    v_xor_b32 v62, s0, v62
    v_or_b32 v64, v64, v62
    v_cmp_ne_u32 vcc, 0, v64
    s_nop 1
    s_bcnt1_i32_b64 s3, vcc
    v_mov_b32 v59, s3
    ds_write_b32 v58, v59
IR_100016:
    s_waitcnt lgkmcnt(0)
    s_barrier
    ds_read_b32 v59, v58
    s_waitcnt lgkmcnt(0)
    v_readfirstlane_b32 s3, v59
    s_barrier
    s_nop 0
    s_cmp_lt_u32 s3, 50
    s_cbranch_scc1 L_P2POLL
    s_cmp_eq_u32 s60, 0
    s_cbranch_scc1 IR_100017
    s_mov_b32 s3, 393216
    buffer_load_dword v86, v56, s[36:39], s3 offen
    s_waitcnt vmcnt(0)
IR_100017:
    s_cmp_lg_u32 s58, 0
    s_cbranch_scc1 IR_100018
    buffer_load_dwordx2 v[62:63], v61, s[52:55], 0 offen sc1
    s_waitcnt vmcnt(0)
    v_xor_b32 v64, s1, v63
    v_and_b32 v64, 0xfffffff, v64
    v_xor_b32 v62, s0, v62
    v_or_b32 v64, v64, v62
    v_cmp_ne_u32 vcc, 0, v64
    s_nop 1
    s_bcnt1_i32_b64 s3, vcc
    v_mov_b32 v59, s3
    ds_write_b32 v58, v59
IR_100018:
    s_waitcnt lgkmcnt(0)
    s_barrier
    ds_read_b32 v59, v58
    s_waitcnt lgkmcnt(0)
    v_readfirstlane_b32 s3, v59
    s_barrier
    s_nop 0
    s_cmp_lt_u32 s3, 50
    s_cbranch_scc1 L_P2POLL
    s_cmp_eq_u32 s60, 0
    s_cbranch_scc1 IR_100019
    s_mov_b32 s3, 524288
    buffer_load_dword v86, v56, s[36:39], s3 offen
    s_waitcnt vmcnt(0)
IR_100019:
    s_cmp_lg_u32 s58, 0
    s_cbranch_scc1 IR_100020
    buffer_load_dwordx2 v[62:63], v61, s[52:55], 0 offen sc1
    s_waitcnt vmcnt(0)
    v_xor_b32 v64, s1, v63
    v_and_b32 v64, 0xfffffff, v64
    v_xor_b32 v62, s0, v62
    v_or_b32 v64, v64, v62
    v_cmp_ne_u32 vcc, 0, v64
    s_nop 1
    s_bcnt1_i32_b64 s3, vcc
    v_mov_b32 v59, s3
    ds_write_b32 v58, v59
IR_100020:
    s_waitcnt lgkmcnt(0)
    s_barrier
    ds_read_b32 v59, v58
    s_waitcnt lgkmcnt(0)
    v_readfirstlane_b32 s3, v59
    s_barrier
    s_nop 0
    s_cmp_lt_u32 s3, 50
    s_cbranch_scc1 L_P2POLL
    s_cmp_eq_u32 s60, 0
    s_cbranch_scc1 IR_100021
    s_mov_b32 s3, 655360
    buffer_load_dword v86, v56, s[36:39], s3 offen
    s_waitcnt vmcnt(0)
IR_100021:
    s_cmp_lg_u32 s58, 0
    s_cbranch_scc1 IR_100022
    buffer_load_dwordx2 v[62:63], v61, s[52:55], 0 offen sc1
    s_waitcnt vmcnt(0)
    v_xor_b32 v64, s1, v63
    v_and_b32 v64, 0xfffffff, v64
    v_xor_b32 v62, s0, v62
    v_or_b32 v64, v64, v62
    v_cmp_ne_u32 vcc, 0, v64
    s_nop 1
    s_bcnt1_i32_b64 s3, vcc
    v_mov_b32 v59, s3
    ds_write_b32 v58, v59
IR_100022:
    s_waitcnt lgkmcnt(0)
    s_barrier
    ds_read_b32 v59, v58
    s_waitcnt lgkmcnt(0)
    v_readfirstlane_b32 s3, v59
    s_barrier
    s_nop 0
    s_cmp_lt_u32 s3, 50
    s_cbranch_scc1 L_P2POLL
    s_cmp_eq_u32 s60, 0
    s_cbranch_scc1 IR_100023
    s_mov_b32 s3, 786432
    buffer_load_dword v86, v56, s[36:39], s3 offen
    s_waitcnt vmcnt(0)
IR_100023:
    s_cmp_lg_u32 s58, 0
    s_cbranch_scc1 IR_100024
    buffer_load_dwordx2 v[62:63], v61, s[52:55], 0 offen sc1
    s_waitcnt vmcnt(0)
    v_xor_b32 v64, s1, v63
    v_and_b32 v64, 0xfffffff, v64
    v_xor_b32 v62, s0, v62
    v_or_b32 v64, v64, v62
    v_cmp_ne_u32 vcc, 0, v64
    s_nop 1
    s_bcnt1_i32_b64 s3, vcc
    v_mov_b32 v59, s3
    ds_write_b32 v58, v59
IR_100024:
    s_waitcnt lgkmcnt(0)
    s_barrier
    ds_read_b32 v59, v58
    s_waitcnt lgkmcnt(0)
    v_readfirstlane_b32 s3, v59
    s_barrier
    s_nop 0
    s_cmp_lt_u32 s3, 50
    s_cbranch_scc1 L_P2POLL
    s_cmp_eq_u32 s60, 0
    s_cbranch_scc1 IR_100025
    s_mov_b32 s3, 917504
    buffer_load_dword v86, v56, s[36:39], s3 offen
    s_waitcnt vmcnt(0)
IR_100025:
    s_cmp_lg_u32 s58, 0
    s_cbranch_scc1 IR_100026
    buffer_load_dwordx2 v[62:63], v61, s[52:55], 0 offen sc1
    s_waitcnt vmcnt(0)
    v_xor_b32 v64, s1, v63
    v_and_b32 v64, 0xfffffff, v64
    v_xor_b32 v62, s0, v62
    v_or_b32 v64, v64, v62
    v_cmp_ne_u32 vcc, 0, v64
    s_nop 1
    s_bcnt1_i32_b64 s3, vcc
    v_mov_b32 v59, s3
    ds_write_b32 v58, v59
IR_100026:
    s_waitcnt lgkmcnt(0)
    s_barrier
    ds_read_b32 v59, v58
    s_waitcnt lgkmcnt(0)
    v_readfirstlane_b32 s3, v59
    s_barrier
    s_nop 0
    s_cmp_lt_u32 s3, 50
    s_cbranch_scc1 L_P2POLL
    s_cmp_eq_u32 s60, 0
    s_cbranch_scc1 IR_100027
    s_mov_b32 s3, 1048576
    buffer_load_dword v86, v56, s[36:39], s3 offen
    s_waitcnt vmcnt(0)
IR_100027:
    s_cmp_lg_u32 s58, 0
    s_cbranch_scc1 IR_100028
    buffer_load_dwordx2 v[62:63], v61, s[52:55], 0 offen sc1
    s_waitcnt vmcnt(0)
    v_xor_b32 v64, s1, v63
    v_and_b32 v64, 0xfffffff, v64
    v_xor_b32 v62, s0, v62
    v_or_b32 v64, v64, v62
    v_cmp_ne_u32 vcc, 0, v64
    s_nop 1
    s_bcnt1_i32_b64 s3, vcc
    v_mov_b32 v59, s3
    ds_write_b32 v58, v59
IR_100028:
    s_waitcnt lgkmcnt(0)
    s_barrier
    ds_read_b32 v59, v58
    s_waitcnt lgkmcnt(0)
    v_readfirstlane_b32 s3, v59
    s_barrier
    s_nop 0
    s_cmp_lt_u32 s3, 50
    s_cbranch_scc1 L_P2POLL
    s_nop 7
    s_branch L_P2POLL
L_CODE_END:

.section .rodata,"a"
.p2align 6
.amdhsa_kernel sequential_preLN__sliding_block__dense_activation_relu__prompt_kernel
  .amdhsa_next_free_vgpr 256
  .amdhsa_next_free_sgpr 102
  .amdhsa_accum_offset 256
  .amdhsa_group_segment_fixed_size 0
  .amdhsa_kernarg_size 72
  .amdhsa_user_sgpr_count 2
  .amdhsa_user_sgpr_kernarg_segment_ptr 1
  .amdhsa_system_sgpr_workgroup_id_x 1
.end_amdhsa_kernel
```
